```python
import torch

def _softmax(x, axis=-1):
    return torch.softmax(x, dim=axis)
def _gelu(x):
    return torch.nn.functional.gelu(x, approximate="tanh")
def _silu(x):
    return torch.nn.functional.silu(x)
def _sigmoid(x):
    return torch.sigmoid(x)
def _layernorm(x, axis=-1, eps=1e-5):
    m = x.mean(dim=axis, keepdim=True)
    v = x.var(dim=axis, keepdim=True, unbiased=False)
    return (x - m) / torch.sqrt(v + eps)
def _scatter_add(tgt, idx, src, axis=0):
    return tgt.clone().index_add_(axis, idx, src)
def _segment_sum(src, seg, n):
    out = torch.zeros((n,) + src.shape[1:], dtype=src.dtype)
    return out.index_add_(0, seg, src)
def _pad(x, pw):
    flat = tuple(v for pair in reversed(pw) for v in pair)
    return torch.nn.functional.pad(x, flat)

kernel_name = 'standalone__molecular_angular_gemnet__graph'

def setup_inputs():

    _w = (lambda a: (lambda t: t.to(torch.bfloat16) if t.is_floating_point() else t)(torch.as_tensor(a)))
    N, deg, De, L = 10000, 32, 16, 1
    E = N * deg
    T = E * deg
    NR = 8
    dist = torch.rand(E).to(float)
    angle = (torch.rand(T) * torch.pi).to(float)
    centers = torch.linspace(0.0, 1.0, NR).to(float)
    ang_freq = torch.arange(1, L + 1).to(float)
    return {
        "m": _w((lambda *s: torch.randn(*s, dtype=torch.bfloat16) * 0.05)(E, De)),
        "idx_in": _w((lambda lo, hi, *s: torch.randint(lo, hi, s))(0, E, T).to(torch.int64)),
        "idx_out": _w((lambda lo, hi, *s: torch.randint(lo, hi, s))(0, E, T).to(torch.int64)),
        "dist": _w(dist),
        "angle": _w(angle),
        "centers": _w(centers),
        "ang_freq": _w(ang_freq),
        "w_rbf": _w((lambda *s: torch.randn(*s, dtype=torch.bfloat16) * 0.2)(NR, De)),
        "w_sbf": _w((lambda *s: torch.randn(*s, dtype=torch.bfloat16) * 0.2)(NR * L, De)),
        "w_down": _w((lambda *s: torch.randn(*s, dtype=torch.bfloat16) * 0.2)(De, De)),
        "w_up": _w((lambda *s: torch.randn(*s, dtype=torch.bfloat16) * 0.2)(De, De)),
    }

def reference(m, idx_in, idx_out, dist, angle, centers, ang_freq, w_rbf, w_sbf, w_down, w_up):
    E, De = m.shape[0], m.shape[1]
    NR = centers.shape[0]
    L = ang_freq.shape[0]
    rbf = torch.exp(-10.0 * (dist[:, None] - centers[None, :]) ** 2)
    cbf = torch.cos(ang_freq[None, :] * angle[:, None])
    rbf_t = rbf[idx_out]
    sbf = torch.reshape(rbf_t[:, :, None] * cbf[:, None, :], (-1, NR * L))
    x = (m[idx_in] @ w_down) * (sbf @ w_sbf)
    agg = _segment_sum(x, idx_out, E)
    return m + (agg @ w_up) * (rbf @ w_rbf)
```

```asm
; @launch kernel=p1_kernel grid=(256,1,1) block=(1024,1,1) lds=163840
; @launch kernel=p2_kernel grid=(256,1,1) block=(1024,1,1) lds=163840
.amdgcn_target "amdgcn-amd-amdhsa--gfx950"
.text
.globl p1_kernel
.globl p2_kernel
.p2align 8
.type p1_kernel,@function
p1_kernel:
  s_cmp_ge_u32 s2, 256
  s_cbranch_scc1 p1_done
  s_load_dwordx4 s[32:35], s[0:1], 8
  s_load_dwordx2 s[36:37], s[0:1], 32
  s_load_dwordx2 s[38:39], s[0:1], 48
  s_load_dwordx2 s[28:29], s[0:1], 104
  s_load_dwordx2 s[74:75], s[0:1], 0
  v_lshlrev_b32 v1, 4, v0
  v_add_u32 v2, 139264, v1
  v_mov_b32 v4, 0
  v_mov_b32 v5, 0
  v_mov_b32 v6, 0
  v_mov_b32 v7, 0
  ds_write_b128 v2, v[4:7]
  ds_write_b128 v2, v[4:7] offset:16384
  s_mul_i32 s40, s2, 160000
  s_mul_i32 s41, s2, 80000
  v_add_u32 v1, s40, v1
  v_lshlrev_b32 v3, 3, v0
  v_add_u32 v3, s41, v3
  v_readfirstlane_b32 s24, v0
  v_cmp_gt_u32 vcc, 1000, v0
  s_lshr_b32 s24, s24, 6
  s_mov_b64 s[44:45], vcc
  s_mov_b32 s46, 16000
  s_mov_b32 s56, 8000
  s_mov_b32 s47, 32000
  s_mov_b32 s57, 16000
  s_mov_b32 s48, 48000
  s_mov_b32 s58, 24000
  s_mov_b32 s49, 64000
  s_mov_b32 s59, 32000
  s_mov_b32 s50, 80000
  s_mov_b32 s60, 40000
  s_mov_b32 s51, 96000
  s_mov_b32 s61, 48000
  s_mov_b32 s52, 112000
  s_mov_b32 s62, 56000
  s_mov_b32 s53, 128000
  s_mov_b32 s63, 64000
  s_mov_b32 s54, 144000
  s_mov_b32 s64, 72000
  s_waitcnt lgkmcnt(0)
  s_load_dword s26, s[38:39], 0
  s_mov_b32 s4, s32
  s_and_b32 s5, s33, 0xffff
  s_mov_b32 s6, 40960000
  s_mov_b32 s7, 0x20000
  s_mov_b32 s8, s34
  s_and_b32 s9, s35, 0xffff
  s_mov_b32 s10, 40960000
  s_mov_b32 s11, 0x20000
  s_mov_b32 s12, s36
  s_and_b32 s13, s37, 0xffff
  s_mov_b32 s14, 20480000
  s_mov_b32 s15, 0x20000
  s_mov_b64 exec, s[44:45]
  buffer_load_dwordx4 v[8:11], v1, s[4:7], 0 offen nt
  buffer_load_dwordx4 v[48:51], v1, s[8:11], 0 offen nt
  buffer_load_dwordx2 v[88:89], v3, s[12:15], 0 offen nt
  buffer_load_dwordx4 v[12:15], v1, s[4:7], s46 offen nt
  buffer_load_dwordx4 v[52:55], v1, s[8:11], s46 offen nt
  buffer_load_dwordx2 v[90:91], v3, s[12:15], s56 offen nt
  s_mov_b32 s27, 0xffff0000
  s_mov_b32 s30, 0x3e22f900
  s_mov_b32 s31, 0x36036e4e
  s_mov_b32 s42, 139264
  s_mov_b32 s43, 0x3fc
  v_mov_b32 v2, 1
  s_mov_b32 s20, s28
  s_and_b32 s21, s29, 0xffff
  s_mov_b32 s22, 262144
  s_mov_b32 s23, 0x20000
  s_mov_b32 s76, s74
  s_and_b32 s77, s75, 0xffff
  s_mov_b32 s78, 10240000
  s_mov_b32 s79, 0x20000
  s_mul_i32 s40, s2, 287232
  s_add_u32 s28, s28, s40
  s_addc_u32 s29, s29, 0
  s_add_u32 s28, s28, 262144
  s_addc_u32 s29, s29, 0
  s_waitcnt lgkmcnt(0)
  s_and_b32 s26, s26, 0xffff
  s_lshl_b32 s26, s26, 16
  s_barrier
  s_mov_b32 s33, 16384
  s_mov_b32 s34, 32768
  s_mov_b32 s35, 49152
  s_mov_b32 s36, 65536
  s_mov_b32 s37, 81920
  s_mov_b32 s38, 98304
  s_mov_b32 s39, 114688
  s_waitcnt vmcnt(3)
  buffer_load_dwordx4 v[16:19], v1, s[4:7], s47 offen nt
  buffer_load_dwordx4 v[56:59], v1, s[8:11], s47 offen nt
  buffer_load_dwordx2 v[92:93], v3, s[12:15], s57 offen nt
  v_lshlrev_b32 v108, 16, v88
  v_and_b32 v109, s27, v88
  v_lshlrev_b32 v110, 16, v89
  v_and_b32 v111, s27, v89
  v_mul_f32 v108, s26, v108
  v_mul_f32 v109, s26, v109
  v_mul_f32 v110, s26, v110
  v_mul_f32 v111, s26, v111
  v_cvt_pk_bf16_f32 v112, v108, v109
  v_cvt_pk_bf16_f32 v113, v110, v111
  v_lshrrev_b32 v116, 8, v48
  v_lshrrev_b32 v117, 8, v49
  v_lshrrev_b32 v118, 8, v50
  v_lshrrev_b32 v119, 8, v51
  v_lshlrev_b32 v108, 16, v112
  v_and_b32 v109, s27, v112
  v_lshlrev_b32 v110, 16, v113
  v_and_b32 v111, s27, v113
  v_bfi_b32 v116, 15, v48, v116
  v_bfi_b32 v117, 15, v49, v117
  v_bfi_b32 v118, 15, v50, v118
  v_bfi_b32 v119, 15, v51, v119
  v_mul_f32 v112, s30, v108
  v_mul_f32 v113, s30, v109
  v_mul_f32 v114, s30, v110
  v_mul_f32 v115, s30, v111
  v_fract_f32 v112, v112
  v_fract_f32 v113, v113
  v_fract_f32 v114, v114
  v_fract_f32 v115, v115
  v_fma_f32 v112, v108, s31, v112
  v_fma_f32 v113, v109, s31, v113
  v_fma_f32 v114, v110, s31, v114
  v_fma_f32 v115, v111, s31, v115
  v_cos_f32 v112, v112
  v_cos_f32 v113, v113
  v_cos_f32 v114, v114
  v_cos_f32 v115, v115
  v_lshrrev_b32 v120, 2, v48
  v_lshrrev_b32 v121, 2, v49
  v_lshrrev_b32 v122, 2, v50
  v_lshrrev_b32 v123, 2, v51
  v_lshrrev_b32 v108, 14, v8
  v_lshrrev_b32 v109, 14, v9
  v_lshrrev_b32 v110, 14, v10
  v_lshrrev_b32 v111, 14, v11
  v_and_b32 v120, s43, v120
  v_and_b32 v121, s43, v121
  v_and_b32 v122, s43, v122
  v_and_b32 v123, s43, v123
  v_lshl_or_b32 v120, v108, 10, v120
  v_lshl_or_b32 v121, v109, 10, v121
  v_lshl_or_b32 v122, v110, 10, v122
  v_lshl_or_b32 v123, v111, 10, v123
  v_cvt_pk_bf16_f32 v124, v112, v113
  v_cvt_pk_bf16_f32 v125, v114, v115
  v_add_u32 v108, s42, v120
  v_add_u32 v109, s42, v121
  v_add_u32 v110, s42, v122
  v_add_u32 v111, s42, v123
  ds_add_u32 v108, v2
  ds_add_u32 v109, v2
  ds_add_u32 v110, v2
  ds_add_u32 v111, v2
  v_lshl_or_b32 v8, v116, 19, v8
  v_lshl_or_b32 v9, v117, 19, v9
  v_lshl_or_b32 v10, v118, 19, v10
  v_lshl_or_b32 v11, v119, 19, v11
  v_mov_b32 v48, v124
  v_mov_b32 v50, v125
  v_lshl_or_b32 v88, v121, 16, v120
  v_lshl_or_b32 v89, v123, 16, v122
  s_waitcnt vmcnt(3)
  buffer_load_dwordx4 v[20:23], v1, s[4:7], s48 offen nt
  buffer_load_dwordx4 v[60:63], v1, s[8:11], s48 offen nt
  buffer_load_dwordx2 v[94:95], v3, s[12:15], s58 offen nt
  v_lshlrev_b32 v108, 16, v90
  v_and_b32 v109, s27, v90
  v_lshlrev_b32 v110, 16, v91
  v_and_b32 v111, s27, v91
  v_mul_f32 v108, s26, v108
  v_mul_f32 v109, s26, v109
  v_mul_f32 v110, s26, v110
  v_mul_f32 v111, s26, v111
  v_cvt_pk_bf16_f32 v112, v108, v109
  v_cvt_pk_bf16_f32 v113, v110, v111
  v_lshrrev_b32 v116, 8, v52
  v_lshrrev_b32 v117, 8, v53
  v_lshrrev_b32 v118, 8, v54
  v_lshrrev_b32 v119, 8, v55
  v_lshlrev_b32 v108, 16, v112
  v_and_b32 v109, s27, v112
  v_lshlrev_b32 v110, 16, v113
  v_and_b32 v111, s27, v113
  v_bfi_b32 v116, 15, v52, v116
  v_bfi_b32 v117, 15, v53, v117
  v_bfi_b32 v118, 15, v54, v118
  v_bfi_b32 v119, 15, v55, v119
  v_mul_f32 v112, s30, v108
  v_mul_f32 v113, s30, v109
  v_mul_f32 v114, s30, v110
  v_mul_f32 v115, s30, v111
  v_fract_f32 v112, v112
  v_fract_f32 v113, v113
  v_fract_f32 v114, v114
  v_fract_f32 v115, v115
  v_fma_f32 v112, v108, s31, v112
  v_fma_f32 v113, v109, s31, v113
  v_fma_f32 v114, v110, s31, v114
  v_fma_f32 v115, v111, s31, v115
  v_cos_f32 v112, v112
  v_cos_f32 v113, v113
  v_cos_f32 v114, v114
  v_cos_f32 v115, v115
  v_lshrrev_b32 v120, 2, v52
  v_lshrrev_b32 v121, 2, v53
  v_lshrrev_b32 v122, 2, v54
  v_lshrrev_b32 v123, 2, v55
  v_lshrrev_b32 v108, 14, v12
  v_lshrrev_b32 v109, 14, v13
  v_lshrrev_b32 v110, 14, v14
  v_lshrrev_b32 v111, 14, v15
  v_and_b32 v120, s43, v120
  v_and_b32 v121, s43, v121
  v_and_b32 v122, s43, v122
  v_and_b32 v123, s43, v123
  v_lshl_or_b32 v120, v108, 10, v120
  v_lshl_or_b32 v121, v109, 10, v121
  v_lshl_or_b32 v122, v110, 10, v122
  v_lshl_or_b32 v123, v111, 10, v123
  v_cvt_pk_bf16_f32 v124, v112, v113
  v_cvt_pk_bf16_f32 v125, v114, v115
  v_add_u32 v108, s42, v120
  v_add_u32 v109, s42, v121
  v_add_u32 v110, s42, v122
  v_add_u32 v111, s42, v123
  ds_add_u32 v108, v2
  ds_add_u32 v109, v2
  ds_add_u32 v110, v2
  ds_add_u32 v111, v2
  v_lshl_or_b32 v12, v116, 19, v12
  v_lshl_or_b32 v13, v117, 19, v13
  v_lshl_or_b32 v14, v118, 19, v14
  v_lshl_or_b32 v15, v119, 19, v15
  v_mov_b32 v52, v124
  v_mov_b32 v54, v125
  v_lshl_or_b32 v90, v121, 16, v120
  v_lshl_or_b32 v91, v123, 16, v122
  s_waitcnt vmcnt(3)
  buffer_load_dwordx4 v[24:27], v1, s[4:7], s49 offen nt
  buffer_load_dwordx4 v[64:67], v1, s[8:11], s49 offen nt
  buffer_load_dwordx2 v[96:97], v3, s[12:15], s59 offen nt
  v_lshlrev_b32 v108, 16, v92
  v_and_b32 v109, s27, v92
  v_lshlrev_b32 v110, 16, v93
  v_and_b32 v111, s27, v93
  v_mul_f32 v108, s26, v108
  v_mul_f32 v109, s26, v109
  v_mul_f32 v110, s26, v110
  v_mul_f32 v111, s26, v111
  v_cvt_pk_bf16_f32 v112, v108, v109
  v_cvt_pk_bf16_f32 v113, v110, v111
  v_lshrrev_b32 v116, 8, v56
  v_lshrrev_b32 v117, 8, v57
  v_lshrrev_b32 v118, 8, v58
  v_lshrrev_b32 v119, 8, v59
  v_lshlrev_b32 v108, 16, v112
  v_and_b32 v109, s27, v112
  v_lshlrev_b32 v110, 16, v113
  v_and_b32 v111, s27, v113
  v_bfi_b32 v116, 15, v56, v116
  v_bfi_b32 v117, 15, v57, v117
  v_bfi_b32 v118, 15, v58, v118
  v_bfi_b32 v119, 15, v59, v119
  v_mul_f32 v112, s30, v108
  v_mul_f32 v113, s30, v109
  v_mul_f32 v114, s30, v110
  v_mul_f32 v115, s30, v111
  v_fract_f32 v112, v112
  v_fract_f32 v113, v113
  v_fract_f32 v114, v114
  v_fract_f32 v115, v115
  v_fma_f32 v112, v108, s31, v112
  v_fma_f32 v113, v109, s31, v113
  v_fma_f32 v114, v110, s31, v114
  v_fma_f32 v115, v111, s31, v115
  v_cos_f32 v112, v112
  v_cos_f32 v113, v113
  v_cos_f32 v114, v114
  v_cos_f32 v115, v115
  v_lshrrev_b32 v120, 2, v56
  v_lshrrev_b32 v121, 2, v57
  v_lshrrev_b32 v122, 2, v58
  v_lshrrev_b32 v123, 2, v59
  v_lshrrev_b32 v108, 14, v16
  v_lshrrev_b32 v109, 14, v17
  v_lshrrev_b32 v110, 14, v18
  v_lshrrev_b32 v111, 14, v19
  v_and_b32 v120, s43, v120
  v_and_b32 v121, s43, v121
  v_and_b32 v122, s43, v122
  v_and_b32 v123, s43, v123
  v_lshl_or_b32 v120, v108, 10, v120
  v_lshl_or_b32 v121, v109, 10, v121
  v_lshl_or_b32 v122, v110, 10, v122
  v_lshl_or_b32 v123, v111, 10, v123
  v_cvt_pk_bf16_f32 v124, v112, v113
  v_cvt_pk_bf16_f32 v125, v114, v115
  v_add_u32 v108, s42, v120
  v_add_u32 v109, s42, v121
  v_add_u32 v110, s42, v122
  v_add_u32 v111, s42, v123
  ds_add_u32 v108, v2
  ds_add_u32 v109, v2
  ds_add_u32 v110, v2
  ds_add_u32 v111, v2
  v_lshl_or_b32 v16, v116, 19, v16
  v_lshl_or_b32 v17, v117, 19, v17
  v_lshl_or_b32 v18, v118, 19, v18
  v_lshl_or_b32 v19, v119, 19, v19
  v_mov_b32 v56, v124
  v_mov_b32 v58, v125
  v_lshl_or_b32 v92, v121, 16, v120
  v_lshl_or_b32 v93, v123, 16, v122
  s_waitcnt vmcnt(3)
  buffer_load_dwordx4 v[28:31], v1, s[4:7], s50 offen nt
  buffer_load_dwordx4 v[68:71], v1, s[8:11], s50 offen nt
  buffer_load_dwordx2 v[98:99], v3, s[12:15], s60 offen nt
  v_lshlrev_b32 v108, 16, v94
  v_and_b32 v109, s27, v94
  v_lshlrev_b32 v110, 16, v95
  v_and_b32 v111, s27, v95
  v_mul_f32 v108, s26, v108
  v_mul_f32 v109, s26, v109
  v_mul_f32 v110, s26, v110
  v_mul_f32 v111, s26, v111
  v_cvt_pk_bf16_f32 v112, v108, v109
  v_cvt_pk_bf16_f32 v113, v110, v111
  v_lshrrev_b32 v116, 8, v60
  v_lshrrev_b32 v117, 8, v61
  v_lshrrev_b32 v118, 8, v62
  v_lshrrev_b32 v119, 8, v63
  v_lshlrev_b32 v108, 16, v112
  v_and_b32 v109, s27, v112
  v_lshlrev_b32 v110, 16, v113
  v_and_b32 v111, s27, v113
  v_bfi_b32 v116, 15, v60, v116
  v_bfi_b32 v117, 15, v61, v117
  v_bfi_b32 v118, 15, v62, v118
  v_bfi_b32 v119, 15, v63, v119
  v_mul_f32 v112, s30, v108
  v_mul_f32 v113, s30, v109
  v_mul_f32 v114, s30, v110
  v_mul_f32 v115, s30, v111
  v_fract_f32 v112, v112
  v_fract_f32 v113, v113
  v_fract_f32 v114, v114
  v_fract_f32 v115, v115
  v_fma_f32 v112, v108, s31, v112
  v_fma_f32 v113, v109, s31, v113
  v_fma_f32 v114, v110, s31, v114
  v_fma_f32 v115, v111, s31, v115
  v_cos_f32 v112, v112
  v_cos_f32 v113, v113
  v_cos_f32 v114, v114
  v_cos_f32 v115, v115
  v_lshrrev_b32 v120, 2, v60
  v_lshrrev_b32 v121, 2, v61
  v_lshrrev_b32 v122, 2, v62
  v_lshrrev_b32 v123, 2, v63
  v_lshrrev_b32 v108, 14, v20
  v_lshrrev_b32 v109, 14, v21
  v_lshrrev_b32 v110, 14, v22
  v_lshrrev_b32 v111, 14, v23
  v_and_b32 v120, s43, v120
  v_and_b32 v121, s43, v121
  v_and_b32 v122, s43, v122
  v_and_b32 v123, s43, v123
  v_lshl_or_b32 v120, v108, 10, v120
  v_lshl_or_b32 v121, v109, 10, v121
  v_lshl_or_b32 v122, v110, 10, v122
  v_lshl_or_b32 v123, v111, 10, v123
  v_cvt_pk_bf16_f32 v124, v112, v113
  v_cvt_pk_bf16_f32 v125, v114, v115
  v_add_u32 v108, s42, v120
  v_add_u32 v109, s42, v121
  v_add_u32 v110, s42, v122
  v_add_u32 v111, s42, v123
  ds_add_u32 v108, v2
  ds_add_u32 v109, v2
  ds_add_u32 v110, v2
  ds_add_u32 v111, v2
  v_lshl_or_b32 v20, v116, 19, v20
  v_lshl_or_b32 v21, v117, 19, v21
  v_lshl_or_b32 v22, v118, 19, v22
  v_lshl_or_b32 v23, v119, 19, v23
  v_mov_b32 v60, v124
  v_mov_b32 v62, v125
  v_lshl_or_b32 v94, v121, 16, v120
  v_lshl_or_b32 v95, v123, 16, v122
  s_waitcnt vmcnt(3)
  buffer_load_dwordx4 v[32:35], v1, s[4:7], s51 offen nt
  buffer_load_dwordx4 v[72:75], v1, s[8:11], s51 offen nt
  buffer_load_dwordx2 v[100:101], v3, s[12:15], s61 offen nt
  v_lshlrev_b32 v108, 16, v96
  v_and_b32 v109, s27, v96
  v_lshlrev_b32 v110, 16, v97
  v_and_b32 v111, s27, v97
  v_mul_f32 v108, s26, v108
  v_mul_f32 v109, s26, v109
  v_mul_f32 v110, s26, v110
  v_mul_f32 v111, s26, v111
  v_cvt_pk_bf16_f32 v112, v108, v109
  v_cvt_pk_bf16_f32 v113, v110, v111
  v_lshrrev_b32 v116, 8, v64
  v_lshrrev_b32 v117, 8, v65
  v_lshrrev_b32 v118, 8, v66
  v_lshrrev_b32 v119, 8, v67
  v_lshlrev_b32 v108, 16, v112
  v_and_b32 v109, s27, v112
  v_lshlrev_b32 v110, 16, v113
  v_and_b32 v111, s27, v113
  v_bfi_b32 v116, 15, v64, v116
  v_bfi_b32 v117, 15, v65, v117
  v_bfi_b32 v118, 15, v66, v118
  v_bfi_b32 v119, 15, v67, v119
  v_mul_f32 v112, s30, v108
  v_mul_f32 v113, s30, v109
  v_mul_f32 v114, s30, v110
  v_mul_f32 v115, s30, v111
  v_fract_f32 v112, v112
  v_fract_f32 v113, v113
  v_fract_f32 v114, v114
  v_fract_f32 v115, v115
  v_fma_f32 v112, v108, s31, v112
  v_fma_f32 v113, v109, s31, v113
  v_fma_f32 v114, v110, s31, v114
  v_fma_f32 v115, v111, s31, v115
  v_cos_f32 v112, v112
  v_cos_f32 v113, v113
  v_cos_f32 v114, v114
  v_cos_f32 v115, v115
  v_lshrrev_b32 v120, 2, v64
  v_lshrrev_b32 v121, 2, v65
  v_lshrrev_b32 v122, 2, v66
  v_lshrrev_b32 v123, 2, v67
  v_lshrrev_b32 v108, 14, v24
  v_lshrrev_b32 v109, 14, v25
  v_lshrrev_b32 v110, 14, v26
  v_lshrrev_b32 v111, 14, v27
  v_and_b32 v120, s43, v120
  v_and_b32 v121, s43, v121
  v_and_b32 v122, s43, v122
  v_and_b32 v123, s43, v123
  v_lshl_or_b32 v120, v108, 10, v120
  v_lshl_or_b32 v121, v109, 10, v121
  v_lshl_or_b32 v122, v110, 10, v122
  v_lshl_or_b32 v123, v111, 10, v123
  v_cvt_pk_bf16_f32 v124, v112, v113
  v_cvt_pk_bf16_f32 v125, v114, v115
  v_add_u32 v108, s42, v120
  v_add_u32 v109, s42, v121
  v_add_u32 v110, s42, v122
  v_add_u32 v111, s42, v123
  ds_add_u32 v108, v2
  ds_add_u32 v109, v2
  ds_add_u32 v110, v2
  ds_add_u32 v111, v2
  v_lshl_or_b32 v24, v116, 19, v24
  v_lshl_or_b32 v25, v117, 19, v25
  v_lshl_or_b32 v26, v118, 19, v26
  v_lshl_or_b32 v27, v119, 19, v27
  v_mov_b32 v64, v124
  v_mov_b32 v66, v125
  v_lshl_or_b32 v96, v121, 16, v120
  v_lshl_or_b32 v97, v123, 16, v122
  s_waitcnt vmcnt(3)
  buffer_load_dwordx4 v[36:39], v1, s[4:7], s52 offen nt
  buffer_load_dwordx4 v[76:79], v1, s[8:11], s52 offen nt
  buffer_load_dwordx2 v[102:103], v3, s[12:15], s62 offen nt
  v_lshlrev_b32 v108, 16, v98
  v_and_b32 v109, s27, v98
  v_lshlrev_b32 v110, 16, v99
  v_and_b32 v111, s27, v99
  v_mul_f32 v108, s26, v108
  v_mul_f32 v109, s26, v109
  v_mul_f32 v110, s26, v110
  v_mul_f32 v111, s26, v111
  v_cvt_pk_bf16_f32 v112, v108, v109
  v_cvt_pk_bf16_f32 v113, v110, v111
  v_lshrrev_b32 v116, 8, v68
  v_lshrrev_b32 v117, 8, v69
  v_lshrrev_b32 v118, 8, v70
  v_lshrrev_b32 v119, 8, v71
  v_lshlrev_b32 v108, 16, v112
  v_and_b32 v109, s27, v112
  v_lshlrev_b32 v110, 16, v113
  v_and_b32 v111, s27, v113
  v_bfi_b32 v116, 15, v68, v116
  v_bfi_b32 v117, 15, v69, v117
  v_bfi_b32 v118, 15, v70, v118
  v_bfi_b32 v119, 15, v71, v119
  v_mul_f32 v112, s30, v108
  v_mul_f32 v113, s30, v109
  v_mul_f32 v114, s30, v110
  v_mul_f32 v115, s30, v111
  v_fract_f32 v112, v112
  v_fract_f32 v113, v113
  v_fract_f32 v114, v114
  v_fract_f32 v115, v115
  v_fma_f32 v112, v108, s31, v112
  v_fma_f32 v113, v109, s31, v113
  v_fma_f32 v114, v110, s31, v114
  v_fma_f32 v115, v111, s31, v115
  v_cos_f32 v112, v112
  v_cos_f32 v113, v113
  v_cos_f32 v114, v114
  v_cos_f32 v115, v115
  v_lshrrev_b32 v120, 2, v68
  v_lshrrev_b32 v121, 2, v69
  v_lshrrev_b32 v122, 2, v70
  v_lshrrev_b32 v123, 2, v71
  v_lshrrev_b32 v108, 14, v28
  v_lshrrev_b32 v109, 14, v29
  v_lshrrev_b32 v110, 14, v30
  v_lshrrev_b32 v111, 14, v31
  v_and_b32 v120, s43, v120
  v_and_b32 v121, s43, v121
  v_and_b32 v122, s43, v122
  v_and_b32 v123, s43, v123
  v_lshl_or_b32 v120, v108, 10, v120
  v_lshl_or_b32 v121, v109, 10, v121
  v_lshl_or_b32 v122, v110, 10, v122
  v_lshl_or_b32 v123, v111, 10, v123
  v_cvt_pk_bf16_f32 v124, v112, v113
  v_cvt_pk_bf16_f32 v125, v114, v115
  v_add_u32 v108, s42, v120
  v_add_u32 v109, s42, v121
  v_add_u32 v110, s42, v122
  v_add_u32 v111, s42, v123
  ds_add_u32 v108, v2
  ds_add_u32 v109, v2
  ds_add_u32 v110, v2
  ds_add_u32 v111, v2
  v_lshl_or_b32 v28, v116, 19, v28
  v_lshl_or_b32 v29, v117, 19, v29
  v_lshl_or_b32 v30, v118, 19, v30
  v_lshl_or_b32 v31, v119, 19, v31
  v_mov_b32 v68, v124
  v_mov_b32 v70, v125
  v_lshl_or_b32 v98, v121, 16, v120
  v_lshl_or_b32 v99, v123, 16, v122
  s_waitcnt vmcnt(3)
  buffer_load_dwordx4 v[40:43], v1, s[4:7], s53 offen nt
  buffer_load_dwordx4 v[80:83], v1, s[8:11], s53 offen nt
  buffer_load_dwordx2 v[104:105], v3, s[12:15], s63 offen nt
  v_lshlrev_b32 v108, 16, v100
  v_and_b32 v109, s27, v100
  v_lshlrev_b32 v110, 16, v101
  v_and_b32 v111, s27, v101
  v_mul_f32 v108, s26, v108
  v_mul_f32 v109, s26, v109
  v_mul_f32 v110, s26, v110
  v_mul_f32 v111, s26, v111
  v_cvt_pk_bf16_f32 v112, v108, v109
  v_cvt_pk_bf16_f32 v113, v110, v111
  v_lshrrev_b32 v116, 8, v72
  v_lshrrev_b32 v117, 8, v73
  v_lshrrev_b32 v118, 8, v74
  v_lshrrev_b32 v119, 8, v75
  v_lshlrev_b32 v108, 16, v112
  v_and_b32 v109, s27, v112
  v_lshlrev_b32 v110, 16, v113
  v_and_b32 v111, s27, v113
  v_bfi_b32 v116, 15, v72, v116
  v_bfi_b32 v117, 15, v73, v117
  v_bfi_b32 v118, 15, v74, v118
  v_bfi_b32 v119, 15, v75, v119
  v_mul_f32 v112, s30, v108
  v_mul_f32 v113, s30, v109
  v_mul_f32 v114, s30, v110
  v_mul_f32 v115, s30, v111
  v_fract_f32 v112, v112
  v_fract_f32 v113, v113
  v_fract_f32 v114, v114
  v_fract_f32 v115, v115
  v_fma_f32 v112, v108, s31, v112
  v_fma_f32 v113, v109, s31, v113
  v_fma_f32 v114, v110, s31, v114
  v_fma_f32 v115, v111, s31, v115
  v_cos_f32 v112, v112
  v_cos_f32 v113, v113
  v_cos_f32 v114, v114
  v_cos_f32 v115, v115
  v_lshrrev_b32 v120, 2, v72
  v_lshrrev_b32 v121, 2, v73
  v_lshrrev_b32 v122, 2, v74
  v_lshrrev_b32 v123, 2, v75
  v_lshrrev_b32 v108, 14, v32
  v_lshrrev_b32 v109, 14, v33
  v_lshrrev_b32 v110, 14, v34
  v_lshrrev_b32 v111, 14, v35
  v_and_b32 v120, s43, v120
  v_and_b32 v121, s43, v121
  v_and_b32 v122, s43, v122
  v_and_b32 v123, s43, v123
  v_lshl_or_b32 v120, v108, 10, v120
  v_lshl_or_b32 v121, v109, 10, v121
  v_lshl_or_b32 v122, v110, 10, v122
  v_lshl_or_b32 v123, v111, 10, v123
  v_cvt_pk_bf16_f32 v124, v112, v113
  v_cvt_pk_bf16_f32 v125, v114, v115
  v_add_u32 v108, s42, v120
  v_add_u32 v109, s42, v121
  v_add_u32 v110, s42, v122
  v_add_u32 v111, s42, v123
  ds_add_u32 v108, v2
  ds_add_u32 v109, v2
  ds_add_u32 v110, v2
  ds_add_u32 v111, v2
  v_lshl_or_b32 v32, v116, 19, v32
  v_lshl_or_b32 v33, v117, 19, v33
  v_lshl_or_b32 v34, v118, 19, v34
  v_lshl_or_b32 v35, v119, 19, v35
  v_mov_b32 v72, v124
  v_mov_b32 v74, v125
  v_lshl_or_b32 v100, v121, 16, v120
  v_lshl_or_b32 v101, v123, 16, v122
  s_waitcnt vmcnt(3)
  buffer_load_dwordx4 v[44:47], v1, s[4:7], s54 offen nt
  buffer_load_dwordx4 v[84:87], v1, s[8:11], s54 offen nt
  buffer_load_dwordx2 v[106:107], v3, s[12:15], s64 offen nt
  v_lshlrev_b32 v108, 16, v102
  v_and_b32 v109, s27, v102
  v_lshlrev_b32 v110, 16, v103
  v_and_b32 v111, s27, v103
  v_mul_f32 v108, s26, v108
  v_mul_f32 v109, s26, v109
  v_mul_f32 v110, s26, v110
  v_mul_f32 v111, s26, v111
  v_cvt_pk_bf16_f32 v112, v108, v109
  v_cvt_pk_bf16_f32 v113, v110, v111
  v_lshrrev_b32 v116, 8, v76
  v_lshrrev_b32 v117, 8, v77
  v_lshrrev_b32 v118, 8, v78
  v_lshrrev_b32 v119, 8, v79
  v_lshlrev_b32 v108, 16, v112
  v_and_b32 v109, s27, v112
  v_lshlrev_b32 v110, 16, v113
  v_and_b32 v111, s27, v113
  v_bfi_b32 v116, 15, v76, v116
  v_bfi_b32 v117, 15, v77, v117
  v_bfi_b32 v118, 15, v78, v118
  v_bfi_b32 v119, 15, v79, v119
  v_mul_f32 v112, s30, v108
  v_mul_f32 v113, s30, v109
  v_mul_f32 v114, s30, v110
  v_mul_f32 v115, s30, v111
  v_fract_f32 v112, v112
  v_fract_f32 v113, v113
  v_fract_f32 v114, v114
  v_fract_f32 v115, v115
  v_fma_f32 v112, v108, s31, v112
  v_fma_f32 v113, v109, s31, v113
  v_fma_f32 v114, v110, s31, v114
  v_fma_f32 v115, v111, s31, v115
  v_cos_f32 v112, v112
  v_cos_f32 v113, v113
  v_cos_f32 v114, v114
  v_cos_f32 v115, v115
  v_lshrrev_b32 v120, 2, v76
  v_lshrrev_b32 v121, 2, v77
  v_lshrrev_b32 v122, 2, v78
  v_lshrrev_b32 v123, 2, v79
  v_lshrrev_b32 v108, 14, v36
  v_lshrrev_b32 v109, 14, v37
  v_lshrrev_b32 v110, 14, v38
  v_lshrrev_b32 v111, 14, v39
  v_and_b32 v120, s43, v120
  v_and_b32 v121, s43, v121
  v_and_b32 v122, s43, v122
  v_and_b32 v123, s43, v123
  v_lshl_or_b32 v120, v108, 10, v120
  v_lshl_or_b32 v121, v109, 10, v121
  v_lshl_or_b32 v122, v110, 10, v122
  v_lshl_or_b32 v123, v111, 10, v123
  v_cvt_pk_bf16_f32 v124, v112, v113
  v_cvt_pk_bf16_f32 v125, v114, v115
  v_add_u32 v108, s42, v120
  v_add_u32 v109, s42, v121
  v_add_u32 v110, s42, v122
  v_add_u32 v111, s42, v123
  ds_add_u32 v108, v2
  ds_add_u32 v109, v2
  ds_add_u32 v110, v2
  ds_add_u32 v111, v2
  v_lshl_or_b32 v36, v116, 19, v36
  v_lshl_or_b32 v37, v117, 19, v37
  v_lshl_or_b32 v38, v118, 19, v38
  v_lshl_or_b32 v39, v119, 19, v39
  v_mov_b32 v76, v124
  v_mov_b32 v78, v125
  v_lshl_or_b32 v102, v121, 16, v120
  v_lshl_or_b32 v103, v123, 16, v122
  s_waitcnt vmcnt(3)
  v_lshlrev_b32 v108, 16, v104
  v_and_b32 v109, s27, v104
  v_lshlrev_b32 v110, 16, v105
  v_and_b32 v111, s27, v105
  v_mul_f32 v108, s26, v108
  v_mul_f32 v109, s26, v109
  v_mul_f32 v110, s26, v110
  v_mul_f32 v111, s26, v111
  v_cvt_pk_bf16_f32 v112, v108, v109
  v_cvt_pk_bf16_f32 v113, v110, v111
  v_lshrrev_b32 v116, 8, v80
  v_lshrrev_b32 v117, 8, v81
  v_lshrrev_b32 v118, 8, v82
  v_lshrrev_b32 v119, 8, v83
  v_lshlrev_b32 v108, 16, v112
  v_and_b32 v109, s27, v112
  v_lshlrev_b32 v110, 16, v113
  v_and_b32 v111, s27, v113
  v_bfi_b32 v116, 15, v80, v116
  v_bfi_b32 v117, 15, v81, v117
  v_bfi_b32 v118, 15, v82, v118
  v_bfi_b32 v119, 15, v83, v119
  v_mul_f32 v112, s30, v108
  v_mul_f32 v113, s30, v109
  v_mul_f32 v114, s30, v110
  v_mul_f32 v115, s30, v111
  v_fract_f32 v112, v112
  v_fract_f32 v113, v113
  v_fract_f32 v114, v114
  v_fract_f32 v115, v115
  v_fma_f32 v112, v108, s31, v112
  v_fma_f32 v113, v109, s31, v113
  v_fma_f32 v114, v110, s31, v114
  v_fma_f32 v115, v111, s31, v115
  v_cos_f32 v112, v112
  v_cos_f32 v113, v113
  v_cos_f32 v114, v114
  v_cos_f32 v115, v115
  v_lshrrev_b32 v120, 2, v80
  v_lshrrev_b32 v121, 2, v81
  v_lshrrev_b32 v122, 2, v82
  v_lshrrev_b32 v123, 2, v83
  v_lshrrev_b32 v108, 14, v40
  v_lshrrev_b32 v109, 14, v41
  v_lshrrev_b32 v110, 14, v42
  v_lshrrev_b32 v111, 14, v43
  v_and_b32 v120, s43, v120
  v_and_b32 v121, s43, v121
  v_and_b32 v122, s43, v122
  v_and_b32 v123, s43, v123
  v_lshl_or_b32 v120, v108, 10, v120
  v_lshl_or_b32 v121, v109, 10, v121
  v_lshl_or_b32 v122, v110, 10, v122
  v_lshl_or_b32 v123, v111, 10, v123
  v_cvt_pk_bf16_f32 v124, v112, v113
  v_cvt_pk_bf16_f32 v125, v114, v115
  v_add_u32 v108, s42, v120
  v_add_u32 v109, s42, v121
  v_add_u32 v110, s42, v122
  v_add_u32 v111, s42, v123
  ds_add_u32 v108, v2
  ds_add_u32 v109, v2
  ds_add_u32 v110, v2
  ds_add_u32 v111, v2
  v_lshl_or_b32 v40, v116, 19, v40
  v_lshl_or_b32 v41, v117, 19, v41
  v_lshl_or_b32 v42, v118, 19, v42
  v_lshl_or_b32 v43, v119, 19, v43
  v_mov_b32 v80, v124
  v_mov_b32 v82, v125
  v_lshl_or_b32 v104, v121, 16, v120
  v_lshl_or_b32 v105, v123, 16, v122
  s_waitcnt vmcnt(0)
  v_lshlrev_b32 v108, 16, v106
  v_and_b32 v109, s27, v106
  v_lshlrev_b32 v110, 16, v107
  v_and_b32 v111, s27, v107
  v_mul_f32 v108, s26, v108
  v_mul_f32 v109, s26, v109
  v_mul_f32 v110, s26, v110
  v_mul_f32 v111, s26, v111
  v_cvt_pk_bf16_f32 v112, v108, v109
  v_cvt_pk_bf16_f32 v113, v110, v111
  v_lshrrev_b32 v116, 8, v84
  v_lshrrev_b32 v117, 8, v85
  v_lshrrev_b32 v118, 8, v86
  v_lshrrev_b32 v119, 8, v87
  v_lshlrev_b32 v108, 16, v112
  v_and_b32 v109, s27, v112
  v_lshlrev_b32 v110, 16, v113
  v_and_b32 v111, s27, v113
  v_bfi_b32 v116, 15, v84, v116
  v_bfi_b32 v117, 15, v85, v117
  v_bfi_b32 v118, 15, v86, v118
  v_bfi_b32 v119, 15, v87, v119
  v_mul_f32 v112, s30, v108
  v_mul_f32 v113, s30, v109
  v_mul_f32 v114, s30, v110
  v_mul_f32 v115, s30, v111
  v_fract_f32 v112, v112
  v_fract_f32 v113, v113
  v_fract_f32 v114, v114
  v_fract_f32 v115, v115
  v_fma_f32 v112, v108, s31, v112
  v_fma_f32 v113, v109, s31, v113
  v_fma_f32 v114, v110, s31, v114
  v_fma_f32 v115, v111, s31, v115
  v_cos_f32 v112, v112
  v_cos_f32 v113, v113
  v_cos_f32 v114, v114
  v_cos_f32 v115, v115
  v_lshrrev_b32 v120, 2, v84
  v_lshrrev_b32 v121, 2, v85
  v_lshrrev_b32 v122, 2, v86
  v_lshrrev_b32 v123, 2, v87
  v_lshrrev_b32 v108, 14, v44
  v_lshrrev_b32 v109, 14, v45
  v_lshrrev_b32 v110, 14, v46
  v_lshrrev_b32 v111, 14, v47
  v_and_b32 v120, s43, v120
  v_and_b32 v121, s43, v121
  v_and_b32 v122, s43, v122
  v_and_b32 v123, s43, v123
  v_lshl_or_b32 v120, v108, 10, v120
  v_lshl_or_b32 v121, v109, 10, v121
  v_lshl_or_b32 v122, v110, 10, v122
  v_lshl_or_b32 v123, v111, 10, v123
  v_cvt_pk_bf16_f32 v124, v112, v113
  v_cvt_pk_bf16_f32 v125, v114, v115
  v_add_u32 v108, s42, v120
  v_add_u32 v109, s42, v121
  v_add_u32 v110, s42, v122
  v_add_u32 v111, s42, v123
  ds_add_u32 v108, v2
  ds_add_u32 v109, v2
  ds_add_u32 v110, v2
  ds_add_u32 v111, v2
  v_lshl_or_b32 v44, v116, 19, v44
  v_lshl_or_b32 v45, v117, 19, v45
  v_lshl_or_b32 v46, v118, 19, v46
  v_lshl_or_b32 v47, v119, 19, v47
  v_mov_b32 v84, v124
  v_mov_b32 v86, v125
  v_lshl_or_b32 v106, v121, 16, v120
  v_lshl_or_b32 v107, v123, 16, v122
  s_mov_b64 exec, -1
  s_waitcnt lgkmcnt(0)
  s_barrier
  s_sub_u32 s40, s24, 4
  s_cmp_ge_u32 s40, 5
  s_cbranch_scc1 p1_nopf
  s_mul_i32 s41, s2, 40000
  s_and_b32 s41, s41, 0xffffff80
  v_subrev_u32 v5, 256, v0
  v_lshlrev_b32 v5, 7, v5
  buffer_load_dword v49, v5, s[76:79], s41 offen
p1_nopf:
  v_lshlrev_b32 v4, 2, v0
  v_add_u32 v4, 139264, v4
  s_cmp_ge_u32 s24, 4
  s_cbranch_scc1 p1_skip1_0
  ds_read_b32 v108, v4 offset:0
  ds_read_b32 v109, v4 offset:1024
  ds_read_b32 v110, v4 offset:2048
  ds_read_b32 v111, v4 offset:3072
  ds_read_b32 v112, v4 offset:4096
  ds_read_b32 v113, v4 offset:5120
  ds_read_b32 v114, v4 offset:6144
  ds_read_b32 v115, v4 offset:7168
  ds_read_b32 v116, v4 offset:8192
  ds_read_b32 v117, v4 offset:9216
  ds_read_b32 v118, v4 offset:10240
  ds_read_b32 v119, v4 offset:11264
  ds_read_b32 v120, v4 offset:12288
  ds_read_b32 v121, v4 offset:13312
  ds_read_b32 v122, v4 offset:14336
  ds_read_b32 v123, v4 offset:15360
  ds_read_b32 v124, v4 offset:16384
  ds_read_b32 v125, v4 offset:17408
  ds_read_b32 v126, v4 offset:18432
  ds_read_b32 v127, v4 offset:19456
  v_mov_b32 v5, 0
  s_waitcnt lgkmcnt(0)
  v_add_u32 v6, v5, v108
  v_mov_b32 v108, v5
  v_add_u32 v5, v6, v109
  v_mov_b32 v109, v6
  v_add_u32 v6, v5, v110
  v_mov_b32 v110, v5
  v_add_u32 v5, v6, v111
  v_mov_b32 v111, v6
  v_add_u32 v6, v5, v112
  v_mov_b32 v112, v5
  v_add_u32 v5, v6, v113
  v_mov_b32 v113, v6
  v_add_u32 v6, v5, v114
  v_mov_b32 v114, v5
  v_add_u32 v5, v6, v115
  v_mov_b32 v115, v6
  v_add_u32 v6, v5, v116
  v_mov_b32 v116, v5
  v_add_u32 v5, v6, v117
  v_mov_b32 v117, v6
  v_add_u32 v6, v5, v118
  v_mov_b32 v118, v5
  v_add_u32 v5, v6, v119
  v_mov_b32 v119, v6
  v_add_u32 v6, v5, v120
  v_mov_b32 v120, v5
  v_add_u32 v5, v6, v121
  v_mov_b32 v121, v6
  v_add_u32 v6, v5, v122
  v_mov_b32 v122, v5
  v_add_u32 v5, v6, v123
  v_mov_b32 v123, v6
  v_add_u32 v6, v5, v124
  v_mov_b32 v124, v5
  v_add_u32 v5, v6, v125
  v_mov_b32 v125, v6
  v_add_u32 v6, v5, v126
  v_mov_b32 v126, v5
  v_add_u32 v5, v6, v127
  v_mov_b32 v127, v6
  v_add_u32 v6, 19, v5
  s_mov_b32 s40, 52429
  v_mul_u32_u24 v6, s40, v6
  v_lshrrev_b32 v6, 20, v6
  v_mov_b32 v7, v6
  s_nop 1
  v_add_u32_dpp v7, v7, v7 row_shr:1 row_mask:0xf bank_mask:0xf bound_ctrl:0
  s_nop 1
  v_add_u32_dpp v7, v7, v7 row_shr:2 row_mask:0xf bank_mask:0xf bound_ctrl:0
  s_nop 1
  v_add_u32_dpp v7, v7, v7 row_shr:4 row_mask:0xf bank_mask:0xf bound_ctrl:0
  s_nop 1
  v_add_u32_dpp v7, v7, v7 row_shr:8 row_mask:0xf bank_mask:0xf bound_ctrl:0
  s_nop 1
  v_add_u32_dpp v7, v7, v7 row_bcast:15 row_mask:0xa bank_mask:0xf
  s_nop 1
  v_add_u32_dpp v7, v7, v7 row_bcast:31 row_mask:0xc bank_mask:0xf
  s_lshl_b32 s40, s24, 2
  s_add_u32 s40, s40, 159744
  v_mov_b32 v3, s40
  s_mov_b32 exec_lo, 0
  s_mov_b32 exec_hi, 0x80000000
  ds_write_b32 v3, v7
  s_mov_b64 exec, -1
p1_skip1_0:
  s_waitcnt lgkmcnt(0)
  s_barrier
  v_mov_b32 v1, 159744
  ds_read2_b32 v[2:3], v1 offset0:0 offset1:1
  s_waitcnt lgkmcnt(0)
  v_readfirstlane_b32 s66, v2
  v_readfirstlane_b32 s67, v3
  ds_read2_b32 v[2:3], v1 offset0:2 offset1:3
  s_waitcnt lgkmcnt(0)
  v_readfirstlane_b32 s68, v2
  v_readfirstlane_b32 s69, v3
  s_nop 3
  s_add_u32 s70, s66, s67
  s_add_u32 s71, s70, s68
  s_add_u32 s72, s71, s69
  s_cmp_ge_u32 s24, 4
  s_cbranch_scc1 p1_skip2_0
  s_mov_b32 s73, 0
  s_cmp_eq_u32 s24, 1
  s_cselect_b32 s73, s66, s73
  s_cmp_eq_u32 s24, 2
  s_cselect_b32 s73, s70, s73
  s_cmp_eq_u32 s24, 3
  s_cselect_b32 s73, s71, s73
  v_sub_u32 v7, v7, v6
  v_add_u32 v7, s73, v7
  v_lshl_or_b32 v5, v7, 16, v5
  v_mul_u32_u24 v7, 20, v7
  v_add_u32 v108, v7, v108
  ds_write_b32 v4, v108 offset:0
  v_add_u32 v109, v7, v109
  ds_write_b32 v4, v109 offset:1024
  v_add_u32 v110, v7, v110
  ds_write_b32 v4, v110 offset:2048
  v_add_u32 v111, v7, v111
  ds_write_b32 v4, v111 offset:3072
  v_add_u32 v112, v7, v112
  ds_write_b32 v4, v112 offset:4096
  v_add_u32 v113, v7, v113
  ds_write_b32 v4, v113 offset:5120
  v_add_u32 v114, v7, v114
  ds_write_b32 v4, v114 offset:6144
  v_add_u32 v115, v7, v115
  ds_write_b32 v4, v115 offset:7168
  v_add_u32 v116, v7, v116
  ds_write_b32 v4, v116 offset:8192
  v_add_u32 v117, v7, v117
  ds_write_b32 v4, v117 offset:9216
  v_add_u32 v118, v7, v118
  ds_write_b32 v4, v118 offset:10240
  v_add_u32 v119, v7, v119
  ds_write_b32 v4, v119 offset:11264
  v_add_u32 v120, v7, v120
  ds_write_b32 v4, v120 offset:12288
  v_add_u32 v121, v7, v121
  ds_write_b32 v4, v121 offset:13312
  v_add_u32 v122, v7, v122
  ds_write_b32 v4, v122 offset:14336
  v_add_u32 v123, v7, v123
  ds_write_b32 v4, v123 offset:15360
  v_add_u32 v124, v7, v124
  ds_write_b32 v4, v124 offset:16384
  v_add_u32 v125, v7, v125
  ds_write_b32 v4, v125 offset:17408
  v_add_u32 v126, v7, v126
  ds_write_b32 v4, v126 offset:18432
  v_add_u32 v127, v7, v127
  ds_write_b32 v4, v127 offset:19456
  s_mul_i32 s40, s2, 4
  s_mov_b32 s41, 1024
  v_mul_lo_u32 v6, v0, s41
  buffer_store_dword v5, v6, s[20:23], s40 offen
p1_skip2_0:
  s_waitcnt lgkmcnt(0)
  s_barrier
  v_mov_b32 v2, 1
  v_mov_b32 v1, 139264
  s_mov_b64 exec, s[44:45]
  v_add_u32_sdwa v4, v1, v88 dst_sel:DWORD dst_unused:UNUSED_PAD src0_sel:DWORD src1_sel:WORD_0
  ds_add_rtn_u32 v108, v4, v2
  v_add_u32_sdwa v5, v1, v88 dst_sel:DWORD dst_unused:UNUSED_PAD src0_sel:DWORD src1_sel:WORD_1
  ds_add_rtn_u32 v109, v5, v2
  v_add_u32_sdwa v6, v1, v89 dst_sel:DWORD dst_unused:UNUSED_PAD src0_sel:DWORD src1_sel:WORD_0
  ds_add_rtn_u32 v110, v6, v2
  v_add_u32_sdwa v7, v1, v89 dst_sel:DWORD dst_unused:UNUSED_PAD src0_sel:DWORD src1_sel:WORD_1
  ds_add_rtn_u32 v111, v7, v2
  v_add_u32_sdwa v4, v1, v90 dst_sel:DWORD dst_unused:UNUSED_PAD src0_sel:DWORD src1_sel:WORD_0
  ds_add_rtn_u32 v112, v4, v2
  v_add_u32_sdwa v5, v1, v90 dst_sel:DWORD dst_unused:UNUSED_PAD src0_sel:DWORD src1_sel:WORD_1
  ds_add_rtn_u32 v113, v5, v2
  v_add_u32_sdwa v6, v1, v91 dst_sel:DWORD dst_unused:UNUSED_PAD src0_sel:DWORD src1_sel:WORD_0
  ds_add_rtn_u32 v114, v6, v2
  v_add_u32_sdwa v7, v1, v91 dst_sel:DWORD dst_unused:UNUSED_PAD src0_sel:DWORD src1_sel:WORD_1
  ds_add_rtn_u32 v115, v7, v2
  v_add_u32_sdwa v4, v1, v92 dst_sel:DWORD dst_unused:UNUSED_PAD src0_sel:DWORD src1_sel:WORD_0
  ds_add_rtn_u32 v116, v4, v2
  v_add_u32_sdwa v5, v1, v92 dst_sel:DWORD dst_unused:UNUSED_PAD src0_sel:DWORD src1_sel:WORD_1
  ds_add_rtn_u32 v117, v5, v2
  v_add_u32_sdwa v6, v1, v93 dst_sel:DWORD dst_unused:UNUSED_PAD src0_sel:DWORD src1_sel:WORD_0
  ds_add_rtn_u32 v118, v6, v2
  v_add_u32_sdwa v7, v1, v93 dst_sel:DWORD dst_unused:UNUSED_PAD src0_sel:DWORD src1_sel:WORD_1
  ds_add_rtn_u32 v119, v7, v2
  v_add_u32_sdwa v4, v1, v94 dst_sel:DWORD dst_unused:UNUSED_PAD src0_sel:DWORD src1_sel:WORD_0
  ds_add_rtn_u32 v120, v4, v2
  v_add_u32_sdwa v5, v1, v94 dst_sel:DWORD dst_unused:UNUSED_PAD src0_sel:DWORD src1_sel:WORD_1
  ds_add_rtn_u32 v121, v5, v2
  v_add_u32_sdwa v6, v1, v95 dst_sel:DWORD dst_unused:UNUSED_PAD src0_sel:DWORD src1_sel:WORD_0
  ds_add_rtn_u32 v122, v6, v2
  v_add_u32_sdwa v7, v1, v95 dst_sel:DWORD dst_unused:UNUSED_PAD src0_sel:DWORD src1_sel:WORD_1
  ds_add_rtn_u32 v123, v7, v2
  s_waitcnt lgkmcnt(8)
  v_lshl_or_b32 v88, v109, 16, v108
  v_lshl_or_b32 v89, v111, 16, v110
  v_lshl_or_b32 v90, v113, 16, v112
  v_lshl_or_b32 v91, v115, 16, v114
  v_add_u32_sdwa v4, v1, v96 dst_sel:DWORD dst_unused:UNUSED_PAD src0_sel:DWORD src1_sel:WORD_0
  ds_add_rtn_u32 v108, v4, v2
  v_add_u32_sdwa v5, v1, v96 dst_sel:DWORD dst_unused:UNUSED_PAD src0_sel:DWORD src1_sel:WORD_1
  ds_add_rtn_u32 v109, v5, v2
  v_add_u32_sdwa v6, v1, v97 dst_sel:DWORD dst_unused:UNUSED_PAD src0_sel:DWORD src1_sel:WORD_0
  ds_add_rtn_u32 v110, v6, v2
  v_add_u32_sdwa v7, v1, v97 dst_sel:DWORD dst_unused:UNUSED_PAD src0_sel:DWORD src1_sel:WORD_1
  ds_add_rtn_u32 v111, v7, v2
  v_add_u32_sdwa v4, v1, v98 dst_sel:DWORD dst_unused:UNUSED_PAD src0_sel:DWORD src1_sel:WORD_0
  ds_add_rtn_u32 v112, v4, v2
  v_add_u32_sdwa v5, v1, v98 dst_sel:DWORD dst_unused:UNUSED_PAD src0_sel:DWORD src1_sel:WORD_1
  ds_add_rtn_u32 v113, v5, v2
  v_add_u32_sdwa v6, v1, v99 dst_sel:DWORD dst_unused:UNUSED_PAD src0_sel:DWORD src1_sel:WORD_0
  ds_add_rtn_u32 v114, v6, v2
  v_add_u32_sdwa v7, v1, v99 dst_sel:DWORD dst_unused:UNUSED_PAD src0_sel:DWORD src1_sel:WORD_1
  ds_add_rtn_u32 v115, v7, v2
  s_waitcnt lgkmcnt(8)
  v_lshl_or_b32 v92, v117, 16, v116
  v_lshl_or_b32 v93, v119, 16, v118
  v_lshl_or_b32 v94, v121, 16, v120
  v_lshl_or_b32 v95, v123, 16, v122
  v_add_u32_sdwa v4, v1, v100 dst_sel:DWORD dst_unused:UNUSED_PAD src0_sel:DWORD src1_sel:WORD_0
  ds_add_rtn_u32 v116, v4, v2
  v_add_u32_sdwa v5, v1, v100 dst_sel:DWORD dst_unused:UNUSED_PAD src0_sel:DWORD src1_sel:WORD_1
  ds_add_rtn_u32 v117, v5, v2
  v_add_u32_sdwa v6, v1, v101 dst_sel:DWORD dst_unused:UNUSED_PAD src0_sel:DWORD src1_sel:WORD_0
  ds_add_rtn_u32 v118, v6, v2
  v_add_u32_sdwa v7, v1, v101 dst_sel:DWORD dst_unused:UNUSED_PAD src0_sel:DWORD src1_sel:WORD_1
  ds_add_rtn_u32 v119, v7, v2
  v_add_u32_sdwa v4, v1, v102 dst_sel:DWORD dst_unused:UNUSED_PAD src0_sel:DWORD src1_sel:WORD_0
  ds_add_rtn_u32 v120, v4, v2
  v_add_u32_sdwa v5, v1, v102 dst_sel:DWORD dst_unused:UNUSED_PAD src0_sel:DWORD src1_sel:WORD_1
  ds_add_rtn_u32 v121, v5, v2
  v_add_u32_sdwa v6, v1, v103 dst_sel:DWORD dst_unused:UNUSED_PAD src0_sel:DWORD src1_sel:WORD_0
  ds_add_rtn_u32 v122, v6, v2
  v_add_u32_sdwa v7, v1, v103 dst_sel:DWORD dst_unused:UNUSED_PAD src0_sel:DWORD src1_sel:WORD_1
  ds_add_rtn_u32 v123, v7, v2
  s_waitcnt lgkmcnt(8)
  v_lshl_or_b32 v96, v109, 16, v108
  v_lshl_or_b32 v97, v111, 16, v110
  v_lshl_or_b32 v98, v113, 16, v112
  v_lshl_or_b32 v99, v115, 16, v114
  v_add_u32_sdwa v4, v1, v104 dst_sel:DWORD dst_unused:UNUSED_PAD src0_sel:DWORD src1_sel:WORD_0
  ds_add_rtn_u32 v108, v4, v2
  v_add_u32_sdwa v5, v1, v104 dst_sel:DWORD dst_unused:UNUSED_PAD src0_sel:DWORD src1_sel:WORD_1
  ds_add_rtn_u32 v109, v5, v2
  v_add_u32_sdwa v6, v1, v105 dst_sel:DWORD dst_unused:UNUSED_PAD src0_sel:DWORD src1_sel:WORD_0
  ds_add_rtn_u32 v110, v6, v2
  v_add_u32_sdwa v7, v1, v105 dst_sel:DWORD dst_unused:UNUSED_PAD src0_sel:DWORD src1_sel:WORD_1
  ds_add_rtn_u32 v111, v7, v2
  v_add_u32_sdwa v4, v1, v106 dst_sel:DWORD dst_unused:UNUSED_PAD src0_sel:DWORD src1_sel:WORD_0
  ds_add_rtn_u32 v112, v4, v2
  v_add_u32_sdwa v5, v1, v106 dst_sel:DWORD dst_unused:UNUSED_PAD src0_sel:DWORD src1_sel:WORD_1
  ds_add_rtn_u32 v113, v5, v2
  v_add_u32_sdwa v6, v1, v107 dst_sel:DWORD dst_unused:UNUSED_PAD src0_sel:DWORD src1_sel:WORD_0
  ds_add_rtn_u32 v114, v6, v2
  v_add_u32_sdwa v7, v1, v107 dst_sel:DWORD dst_unused:UNUSED_PAD src0_sel:DWORD src1_sel:WORD_1
  ds_add_rtn_u32 v115, v7, v2
  s_waitcnt lgkmcnt(8)
  v_lshl_or_b32 v100, v117, 16, v116
  v_lshl_or_b32 v101, v119, 16, v118
  v_lshl_or_b32 v102, v121, 16, v120
  v_lshl_or_b32 v103, v123, 16, v122
  s_waitcnt lgkmcnt(0)
  v_lshl_or_b32 v104, v109, 16, v108
  v_lshl_or_b32 v105, v111, 16, v110
  v_lshl_or_b32 v106, v113, 16, v112
  v_lshl_or_b32 v107, v115, 16, v114
  s_mov_b64 exec, -1
  s_mov_b32 s43, 23040
  s_mov_b32 s41, 92160
  v_lshrrev_b32 v1, 3, v0
  v_and_b32 v3, 7, v0
  v_mul_u32_u24 v124, 80, v1
  v_lshl_add_u32 v124, v3, 4, v124
  v_mul_u32_u24 v125, 40, v1
  v_lshl_add_u32 v125, v3, 4, v125
  v_add_u32 v125, 92080, v125
  v_cmp_le_u32 vcc, 5, v3
  v_mov_b32 v127, 10240
  v_mov_b32 v1, 5120
  v_cndmask_b32 v124, v124, v125, vcc
  v_cndmask_b32 v125, v127, v1, vcc
  s_mov_b64 exec, s[44:45]
  s_mov_b32 s42, 0
  v_subrev_u32_sdwa v4, s42, v88 dst_sel:DWORD dst_unused:UNUSED_PAD src0_sel:DWORD src1_sel:WORD_0
  v_cmpx_gt_u32 vcc, s43, v4
  v_lshlrev_b32 v5, 2, v4
  v_lshl_add_u32 v4, v4, 1, s41
  ds_write_b32 v5, v8
  ds_write_b16 v4, v48
  s_mov_b64 exec, s[44:45]
  v_subrev_u32_sdwa v6, s42, v88 dst_sel:DWORD dst_unused:UNUSED_PAD src0_sel:DWORD src1_sel:WORD_1
  v_cmpx_gt_u32 vcc, s43, v6
  v_lshlrev_b32 v7, 2, v6
  v_lshl_add_u32 v6, v6, 1, s41
  ds_write_b32 v7, v9
  ds_write_b16_d16_hi v6, v48
  s_mov_b64 exec, s[44:45]
  v_subrev_u32_sdwa v4, s42, v89 dst_sel:DWORD dst_unused:UNUSED_PAD src0_sel:DWORD src1_sel:WORD_0
  v_cmpx_gt_u32 vcc, s43, v4
  v_lshlrev_b32 v5, 2, v4
  v_lshl_add_u32 v4, v4, 1, s41
  ds_write_b32 v5, v10
  ds_write_b16 v4, v50
  s_mov_b64 exec, s[44:45]
  v_subrev_u32_sdwa v6, s42, v89 dst_sel:DWORD dst_unused:UNUSED_PAD src0_sel:DWORD src1_sel:WORD_1
  v_cmpx_gt_u32 vcc, s43, v6
  v_lshlrev_b32 v7, 2, v6
  v_lshl_add_u32 v6, v6, 1, s41
  ds_write_b32 v7, v11
  ds_write_b16_d16_hi v6, v50
  s_mov_b64 exec, s[44:45]
  v_subrev_u32_sdwa v4, s42, v90 dst_sel:DWORD dst_unused:UNUSED_PAD src0_sel:DWORD src1_sel:WORD_0
  v_cmpx_gt_u32 vcc, s43, v4
  v_lshlrev_b32 v5, 2, v4
  v_lshl_add_u32 v4, v4, 1, s41
  ds_write_b32 v5, v12
  ds_write_b16 v4, v52
  s_mov_b64 exec, s[44:45]
  v_subrev_u32_sdwa v6, s42, v90 dst_sel:DWORD dst_unused:UNUSED_PAD src0_sel:DWORD src1_sel:WORD_1
  v_cmpx_gt_u32 vcc, s43, v6
  v_lshlrev_b32 v7, 2, v6
  v_lshl_add_u32 v6, v6, 1, s41
  ds_write_b32 v7, v13
  ds_write_b16_d16_hi v6, v52
  s_mov_b64 exec, s[44:45]
  v_subrev_u32_sdwa v4, s42, v91 dst_sel:DWORD dst_unused:UNUSED_PAD src0_sel:DWORD src1_sel:WORD_0
  v_cmpx_gt_u32 vcc, s43, v4
  v_lshlrev_b32 v5, 2, v4
  v_lshl_add_u32 v4, v4, 1, s41
  ds_write_b32 v5, v14
  ds_write_b16 v4, v54
  s_mov_b64 exec, s[44:45]
  v_subrev_u32_sdwa v6, s42, v91 dst_sel:DWORD dst_unused:UNUSED_PAD src0_sel:DWORD src1_sel:WORD_1
  v_cmpx_gt_u32 vcc, s43, v6
  v_lshlrev_b32 v7, 2, v6
  v_lshl_add_u32 v6, v6, 1, s41
  ds_write_b32 v7, v15
  ds_write_b16_d16_hi v6, v54
  s_mov_b64 exec, s[44:45]
  v_subrev_u32_sdwa v4, s42, v92 dst_sel:DWORD dst_unused:UNUSED_PAD src0_sel:DWORD src1_sel:WORD_0
  v_cmpx_gt_u32 vcc, s43, v4
  v_lshlrev_b32 v5, 2, v4
  v_lshl_add_u32 v4, v4, 1, s41
  ds_write_b32 v5, v16
  ds_write_b16 v4, v56
  s_mov_b64 exec, s[44:45]
  v_subrev_u32_sdwa v6, s42, v92 dst_sel:DWORD dst_unused:UNUSED_PAD src0_sel:DWORD src1_sel:WORD_1
  v_cmpx_gt_u32 vcc, s43, v6
  v_lshlrev_b32 v7, 2, v6
  v_lshl_add_u32 v6, v6, 1, s41
  ds_write_b32 v7, v17
  ds_write_b16_d16_hi v6, v56
  s_mov_b64 exec, s[44:45]
  v_subrev_u32_sdwa v4, s42, v93 dst_sel:DWORD dst_unused:UNUSED_PAD src0_sel:DWORD src1_sel:WORD_0
  v_cmpx_gt_u32 vcc, s43, v4
  v_lshlrev_b32 v5, 2, v4
  v_lshl_add_u32 v4, v4, 1, s41
  ds_write_b32 v5, v18
  ds_write_b16 v4, v58
  s_mov_b64 exec, s[44:45]
  v_subrev_u32_sdwa v6, s42, v93 dst_sel:DWORD dst_unused:UNUSED_PAD src0_sel:DWORD src1_sel:WORD_1
  v_cmpx_gt_u32 vcc, s43, v6
  v_lshlrev_b32 v7, 2, v6
  v_lshl_add_u32 v6, v6, 1, s41
  ds_write_b32 v7, v19
  ds_write_b16_d16_hi v6, v58
  s_mov_b64 exec, s[44:45]
  v_subrev_u32_sdwa v4, s42, v94 dst_sel:DWORD dst_unused:UNUSED_PAD src0_sel:DWORD src1_sel:WORD_0
  v_cmpx_gt_u32 vcc, s43, v4
  v_lshlrev_b32 v5, 2, v4
  v_lshl_add_u32 v4, v4, 1, s41
  ds_write_b32 v5, v20
  ds_write_b16 v4, v60
  s_mov_b64 exec, s[44:45]
  v_subrev_u32_sdwa v6, s42, v94 dst_sel:DWORD dst_unused:UNUSED_PAD src0_sel:DWORD src1_sel:WORD_1
  v_cmpx_gt_u32 vcc, s43, v6
  v_lshlrev_b32 v7, 2, v6
  v_lshl_add_u32 v6, v6, 1, s41
  ds_write_b32 v7, v21
  ds_write_b16_d16_hi v6, v60
  s_mov_b64 exec, s[44:45]
  v_subrev_u32_sdwa v4, s42, v95 dst_sel:DWORD dst_unused:UNUSED_PAD src0_sel:DWORD src1_sel:WORD_0
  v_cmpx_gt_u32 vcc, s43, v4
  v_lshlrev_b32 v5, 2, v4
  v_lshl_add_u32 v4, v4, 1, s41
  ds_write_b32 v5, v22
  ds_write_b16 v4, v62
  s_mov_b64 exec, s[44:45]
  v_subrev_u32_sdwa v6, s42, v95 dst_sel:DWORD dst_unused:UNUSED_PAD src0_sel:DWORD src1_sel:WORD_1
  v_cmpx_gt_u32 vcc, s43, v6
  v_lshlrev_b32 v7, 2, v6
  v_lshl_add_u32 v6, v6, 1, s41
  ds_write_b32 v7, v23
  ds_write_b16_d16_hi v6, v62
  s_mov_b64 exec, s[44:45]
  v_subrev_u32_sdwa v4, s42, v96 dst_sel:DWORD dst_unused:UNUSED_PAD src0_sel:DWORD src1_sel:WORD_0
  v_cmpx_gt_u32 vcc, s43, v4
  v_lshlrev_b32 v5, 2, v4
  v_lshl_add_u32 v4, v4, 1, s41
  ds_write_b32 v5, v24
  ds_write_b16 v4, v64
  s_mov_b64 exec, s[44:45]
  v_subrev_u32_sdwa v6, s42, v96 dst_sel:DWORD dst_unused:UNUSED_PAD src0_sel:DWORD src1_sel:WORD_1
  v_cmpx_gt_u32 vcc, s43, v6
  v_lshlrev_b32 v7, 2, v6
  v_lshl_add_u32 v6, v6, 1, s41
  ds_write_b32 v7, v25
  ds_write_b16_d16_hi v6, v64
  s_mov_b64 exec, s[44:45]
  v_subrev_u32_sdwa v4, s42, v97 dst_sel:DWORD dst_unused:UNUSED_PAD src0_sel:DWORD src1_sel:WORD_0
  v_cmpx_gt_u32 vcc, s43, v4
  v_lshlrev_b32 v5, 2, v4
  v_lshl_add_u32 v4, v4, 1, s41
  ds_write_b32 v5, v26
  ds_write_b16 v4, v66
  s_mov_b64 exec, s[44:45]
  v_subrev_u32_sdwa v6, s42, v97 dst_sel:DWORD dst_unused:UNUSED_PAD src0_sel:DWORD src1_sel:WORD_1
  v_cmpx_gt_u32 vcc, s43, v6
  v_lshlrev_b32 v7, 2, v6
  v_lshl_add_u32 v6, v6, 1, s41
  ds_write_b32 v7, v27
  ds_write_b16_d16_hi v6, v66
  s_mov_b64 exec, s[44:45]
  v_subrev_u32_sdwa v4, s42, v98 dst_sel:DWORD dst_unused:UNUSED_PAD src0_sel:DWORD src1_sel:WORD_0
  v_cmpx_gt_u32 vcc, s43, v4
  v_lshlrev_b32 v5, 2, v4
  v_lshl_add_u32 v4, v4, 1, s41
  ds_write_b32 v5, v28
  ds_write_b16 v4, v68
  s_mov_b64 exec, s[44:45]
  v_subrev_u32_sdwa v6, s42, v98 dst_sel:DWORD dst_unused:UNUSED_PAD src0_sel:DWORD src1_sel:WORD_1
  v_cmpx_gt_u32 vcc, s43, v6
  v_lshlrev_b32 v7, 2, v6
  v_lshl_add_u32 v6, v6, 1, s41
  ds_write_b32 v7, v29
  ds_write_b16_d16_hi v6, v68
  s_mov_b64 exec, s[44:45]
  v_subrev_u32_sdwa v4, s42, v99 dst_sel:DWORD dst_unused:UNUSED_PAD src0_sel:DWORD src1_sel:WORD_0
  v_cmpx_gt_u32 vcc, s43, v4
  v_lshlrev_b32 v5, 2, v4
  v_lshl_add_u32 v4, v4, 1, s41
  ds_write_b32 v5, v30
  ds_write_b16 v4, v70
  s_mov_b64 exec, s[44:45]
  v_subrev_u32_sdwa v6, s42, v99 dst_sel:DWORD dst_unused:UNUSED_PAD src0_sel:DWORD src1_sel:WORD_1
  v_cmpx_gt_u32 vcc, s43, v6
  v_lshlrev_b32 v7, 2, v6
  v_lshl_add_u32 v6, v6, 1, s41
  ds_write_b32 v7, v31
  ds_write_b16_d16_hi v6, v70
  s_mov_b64 exec, s[44:45]
  v_subrev_u32_sdwa v4, s42, v100 dst_sel:DWORD dst_unused:UNUSED_PAD src0_sel:DWORD src1_sel:WORD_0
  v_cmpx_gt_u32 vcc, s43, v4
  v_lshlrev_b32 v5, 2, v4
  v_lshl_add_u32 v4, v4, 1, s41
  ds_write_b32 v5, v32
  ds_write_b16 v4, v72
  s_mov_b64 exec, s[44:45]
  v_subrev_u32_sdwa v6, s42, v100 dst_sel:DWORD dst_unused:UNUSED_PAD src0_sel:DWORD src1_sel:WORD_1
  v_cmpx_gt_u32 vcc, s43, v6
  v_lshlrev_b32 v7, 2, v6
  v_lshl_add_u32 v6, v6, 1, s41
  ds_write_b32 v7, v33
  ds_write_b16_d16_hi v6, v72
  s_mov_b64 exec, s[44:45]
  v_subrev_u32_sdwa v4, s42, v101 dst_sel:DWORD dst_unused:UNUSED_PAD src0_sel:DWORD src1_sel:WORD_0
  v_cmpx_gt_u32 vcc, s43, v4
  v_lshlrev_b32 v5, 2, v4
  v_lshl_add_u32 v4, v4, 1, s41
  ds_write_b32 v5, v34
  ds_write_b16 v4, v74
  s_mov_b64 exec, s[44:45]
  v_subrev_u32_sdwa v6, s42, v101 dst_sel:DWORD dst_unused:UNUSED_PAD src0_sel:DWORD src1_sel:WORD_1
  v_cmpx_gt_u32 vcc, s43, v6
  v_lshlrev_b32 v7, 2, v6
  v_lshl_add_u32 v6, v6, 1, s41
  ds_write_b32 v7, v35
  ds_write_b16_d16_hi v6, v74
  s_mov_b64 exec, s[44:45]
  v_subrev_u32_sdwa v4, s42, v102 dst_sel:DWORD dst_unused:UNUSED_PAD src0_sel:DWORD src1_sel:WORD_0
  v_cmpx_gt_u32 vcc, s43, v4
  v_lshlrev_b32 v5, 2, v4
  v_lshl_add_u32 v4, v4, 1, s41
  ds_write_b32 v5, v36
  ds_write_b16 v4, v76
  s_mov_b64 exec, s[44:45]
  v_subrev_u32_sdwa v6, s42, v102 dst_sel:DWORD dst_unused:UNUSED_PAD src0_sel:DWORD src1_sel:WORD_1
  v_cmpx_gt_u32 vcc, s43, v6
  v_lshlrev_b32 v7, 2, v6
  v_lshl_add_u32 v6, v6, 1, s41
  ds_write_b32 v7, v37
  ds_write_b16_d16_hi v6, v76
  s_mov_b64 exec, s[44:45]
  v_subrev_u32_sdwa v4, s42, v103 dst_sel:DWORD dst_unused:UNUSED_PAD src0_sel:DWORD src1_sel:WORD_0
  v_cmpx_gt_u32 vcc, s43, v4
  v_lshlrev_b32 v5, 2, v4
  v_lshl_add_u32 v4, v4, 1, s41
  ds_write_b32 v5, v38
  ds_write_b16 v4, v78
  s_mov_b64 exec, s[44:45]
  v_subrev_u32_sdwa v6, s42, v103 dst_sel:DWORD dst_unused:UNUSED_PAD src0_sel:DWORD src1_sel:WORD_1
  v_cmpx_gt_u32 vcc, s43, v6
  v_lshlrev_b32 v7, 2, v6
  v_lshl_add_u32 v6, v6, 1, s41
  ds_write_b32 v7, v39
  ds_write_b16_d16_hi v6, v78
  s_mov_b64 exec, s[44:45]
  v_subrev_u32_sdwa v4, s42, v104 dst_sel:DWORD dst_unused:UNUSED_PAD src0_sel:DWORD src1_sel:WORD_0
  v_cmpx_gt_u32 vcc, s43, v4
  v_lshlrev_b32 v5, 2, v4
  v_lshl_add_u32 v4, v4, 1, s41
  ds_write_b32 v5, v40
  ds_write_b16 v4, v80
  s_mov_b64 exec, s[44:45]
  v_subrev_u32_sdwa v6, s42, v104 dst_sel:DWORD dst_unused:UNUSED_PAD src0_sel:DWORD src1_sel:WORD_1
  v_cmpx_gt_u32 vcc, s43, v6
  v_lshlrev_b32 v7, 2, v6
  v_lshl_add_u32 v6, v6, 1, s41
  ds_write_b32 v7, v41
  ds_write_b16_d16_hi v6, v80
  s_mov_b64 exec, s[44:45]
  v_subrev_u32_sdwa v4, s42, v105 dst_sel:DWORD dst_unused:UNUSED_PAD src0_sel:DWORD src1_sel:WORD_0
  v_cmpx_gt_u32 vcc, s43, v4
  v_lshlrev_b32 v5, 2, v4
  v_lshl_add_u32 v4, v4, 1, s41
  ds_write_b32 v5, v42
  ds_write_b16 v4, v82
  s_mov_b64 exec, s[44:45]
  v_subrev_u32_sdwa v6, s42, v105 dst_sel:DWORD dst_unused:UNUSED_PAD src0_sel:DWORD src1_sel:WORD_1
  v_cmpx_gt_u32 vcc, s43, v6
  v_lshlrev_b32 v7, 2, v6
  v_lshl_add_u32 v6, v6, 1, s41
  ds_write_b32 v7, v43
  ds_write_b16_d16_hi v6, v82
  s_mov_b64 exec, s[44:45]
  v_subrev_u32_sdwa v4, s42, v106 dst_sel:DWORD dst_unused:UNUSED_PAD src0_sel:DWORD src1_sel:WORD_0
  v_cmpx_gt_u32 vcc, s43, v4
  v_lshlrev_b32 v5, 2, v4
  v_lshl_add_u32 v4, v4, 1, s41
  ds_write_b32 v5, v44
  ds_write_b16 v4, v84
  s_mov_b64 exec, s[44:45]
  v_subrev_u32_sdwa v6, s42, v106 dst_sel:DWORD dst_unused:UNUSED_PAD src0_sel:DWORD src1_sel:WORD_1
  v_cmpx_gt_u32 vcc, s43, v6
  v_lshlrev_b32 v7, 2, v6
  v_lshl_add_u32 v6, v6, 1, s41
  ds_write_b32 v7, v45
  ds_write_b16_d16_hi v6, v84
  s_mov_b64 exec, s[44:45]
  v_subrev_u32_sdwa v4, s42, v107 dst_sel:DWORD dst_unused:UNUSED_PAD src0_sel:DWORD src1_sel:WORD_0
  v_cmpx_gt_u32 vcc, s43, v4
  v_lshlrev_b32 v5, 2, v4
  v_lshl_add_u32 v4, v4, 1, s41
  ds_write_b32 v5, v46
  ds_write_b16 v4, v86
  s_mov_b64 exec, s[44:45]
  v_subrev_u32_sdwa v6, s42, v107 dst_sel:DWORD dst_unused:UNUSED_PAD src0_sel:DWORD src1_sel:WORD_1
  v_cmpx_gt_u32 vcc, s43, v6
  v_lshlrev_b32 v7, 2, v6
  v_lshl_add_u32 v6, v6, 1, s41
  ds_write_b32 v7, v47
  ds_write_b16_d16_hi v6, v86
  s_mov_b64 exec, s[44:45]
  s_mov_b64 exec, -1
  s_add_u32 s16, s28, 0
  s_addc_u32 s17, s29, 0
  s_and_b32 s17, s17, 0xffff
  s_mov_b32 s18, 147456
  s_mov_b32 s19, 0x20000
  v_lshlrev_b32 v1, 4, v0
  v_mov_b32 v3, v124
  s_mov_b32 s40, 131072
  s_waitcnt lgkmcnt(0)
  s_barrier
  ds_read2_b64 v[108:111], v3 offset0:0 offset1:1
  v_add_u32 v3, v3, v125
  ds_read2_b64 v[112:115], v3 offset0:0 offset1:1
  v_add_u32 v3, v3, v125
  ds_read2_b64 v[116:119], v3 offset0:0 offset1:1
  v_add_u32 v3, v3, v125
  ds_read2_b64 v[120:123], v3 offset0:0 offset1:1
  v_add_u32 v3, v3, v125
  s_waitcnt lgkmcnt(3)
  buffer_store_dwordx4 v[108:111], v1, s[16:19], 0 offen sc1
  s_waitcnt lgkmcnt(2)
  buffer_store_dwordx4 v[112:115], v1, s[16:19], s33 offen sc1
  s_waitcnt lgkmcnt(1)
  buffer_store_dwordx4 v[116:119], v1, s[16:19], s34 offen sc1
  s_waitcnt lgkmcnt(0)
  buffer_store_dwordx4 v[120:123], v1, s[16:19], s35 offen sc1
  s_nop 1
  ds_read2_b64 v[108:111], v3 offset0:0 offset1:1
  v_add_u32 v3, v3, v125
  ds_read2_b64 v[112:115], v3 offset0:0 offset1:1
  v_add_u32 v3, v3, v125
  ds_read2_b64 v[116:119], v3 offset0:0 offset1:1
  v_add_u32 v3, v3, v125
  ds_read2_b64 v[120:123], v3 offset0:0 offset1:1
  v_add_u32 v3, v3, v125
  s_waitcnt lgkmcnt(3)
  buffer_store_dwordx4 v[108:111], v1, s[16:19], s36 offen sc1
  s_waitcnt lgkmcnt(2)
  buffer_store_dwordx4 v[112:115], v1, s[16:19], s37 offen sc1
  s_waitcnt lgkmcnt(1)
  buffer_store_dwordx4 v[116:119], v1, s[16:19], s38 offen sc1
  s_waitcnt lgkmcnt(0)
  buffer_store_dwordx4 v[120:123], v1, s[16:19], s39 offen sc1
  s_nop 1
  ds_read2_b64 v[108:111], v3 offset0:0 offset1:1
  v_add_u32 v3, v3, v125
  s_waitcnt lgkmcnt(0)
  buffer_store_dwordx4 v[108:111], v1, s[16:19], s40 offen sc1
  s_nop 1
  s_barrier
  s_mov_b64 exec, s[44:45]
  s_mov_b32 s42, 23040
  v_subrev_u32_sdwa v4, s42, v88 dst_sel:DWORD dst_unused:UNUSED_PAD src0_sel:DWORD src1_sel:WORD_0
  v_cmpx_gt_u32 vcc, s43, v4
  v_lshlrev_b32 v5, 2, v4
  v_lshl_add_u32 v4, v4, 1, s41
  ds_write_b32 v5, v8
  ds_write_b16 v4, v48
  s_mov_b64 exec, s[44:45]
  v_subrev_u32_sdwa v6, s42, v88 dst_sel:DWORD dst_unused:UNUSED_PAD src0_sel:DWORD src1_sel:WORD_1
  v_cmpx_gt_u32 vcc, s43, v6
  v_lshlrev_b32 v7, 2, v6
  v_lshl_add_u32 v6, v6, 1, s41
  ds_write_b32 v7, v9
  ds_write_b16_d16_hi v6, v48
  s_mov_b64 exec, s[44:45]
  v_subrev_u32_sdwa v4, s42, v89 dst_sel:DWORD dst_unused:UNUSED_PAD src0_sel:DWORD src1_sel:WORD_0
  v_cmpx_gt_u32 vcc, s43, v4
  v_lshlrev_b32 v5, 2, v4
  v_lshl_add_u32 v4, v4, 1, s41
  ds_write_b32 v5, v10
  ds_write_b16 v4, v50
  s_mov_b64 exec, s[44:45]
  v_subrev_u32_sdwa v6, s42, v89 dst_sel:DWORD dst_unused:UNUSED_PAD src0_sel:DWORD src1_sel:WORD_1
  v_cmpx_gt_u32 vcc, s43, v6
  v_lshlrev_b32 v7, 2, v6
  v_lshl_add_u32 v6, v6, 1, s41
  ds_write_b32 v7, v11
  ds_write_b16_d16_hi v6, v50
  s_mov_b64 exec, s[44:45]
  v_subrev_u32_sdwa v4, s42, v90 dst_sel:DWORD dst_unused:UNUSED_PAD src0_sel:DWORD src1_sel:WORD_0
  v_cmpx_gt_u32 vcc, s43, v4
  v_lshlrev_b32 v5, 2, v4
  v_lshl_add_u32 v4, v4, 1, s41
  ds_write_b32 v5, v12
  ds_write_b16 v4, v52
  s_mov_b64 exec, s[44:45]
  v_subrev_u32_sdwa v6, s42, v90 dst_sel:DWORD dst_unused:UNUSED_PAD src0_sel:DWORD src1_sel:WORD_1
  v_cmpx_gt_u32 vcc, s43, v6
  v_lshlrev_b32 v7, 2, v6
  v_lshl_add_u32 v6, v6, 1, s41
  ds_write_b32 v7, v13
  ds_write_b16_d16_hi v6, v52
  s_mov_b64 exec, s[44:45]
  v_subrev_u32_sdwa v4, s42, v91 dst_sel:DWORD dst_unused:UNUSED_PAD src0_sel:DWORD src1_sel:WORD_0
  v_cmpx_gt_u32 vcc, s43, v4
  v_lshlrev_b32 v5, 2, v4
  v_lshl_add_u32 v4, v4, 1, s41
  ds_write_b32 v5, v14
  ds_write_b16 v4, v54
  s_mov_b64 exec, s[44:45]
  v_subrev_u32_sdwa v6, s42, v91 dst_sel:DWORD dst_unused:UNUSED_PAD src0_sel:DWORD src1_sel:WORD_1
  v_cmpx_gt_u32 vcc, s43, v6
  v_lshlrev_b32 v7, 2, v6
  v_lshl_add_u32 v6, v6, 1, s41
  ds_write_b32 v7, v15
  ds_write_b16_d16_hi v6, v54
  s_mov_b64 exec, s[44:45]
  v_subrev_u32_sdwa v4, s42, v92 dst_sel:DWORD dst_unused:UNUSED_PAD src0_sel:DWORD src1_sel:WORD_0
  v_cmpx_gt_u32 vcc, s43, v4
  v_lshlrev_b32 v5, 2, v4
  v_lshl_add_u32 v4, v4, 1, s41
  ds_write_b32 v5, v16
  ds_write_b16 v4, v56
  s_mov_b64 exec, s[44:45]
  v_subrev_u32_sdwa v6, s42, v92 dst_sel:DWORD dst_unused:UNUSED_PAD src0_sel:DWORD src1_sel:WORD_1
  v_cmpx_gt_u32 vcc, s43, v6
  v_lshlrev_b32 v7, 2, v6
  v_lshl_add_u32 v6, v6, 1, s41
  ds_write_b32 v7, v17
  ds_write_b16_d16_hi v6, v56
  s_mov_b64 exec, s[44:45]
  v_subrev_u32_sdwa v4, s42, v93 dst_sel:DWORD dst_unused:UNUSED_PAD src0_sel:DWORD src1_sel:WORD_0
  v_cmpx_gt_u32 vcc, s43, v4
  v_lshlrev_b32 v5, 2, v4
  v_lshl_add_u32 v4, v4, 1, s41
  ds_write_b32 v5, v18
  ds_write_b16 v4, v58
  s_mov_b64 exec, s[44:45]
  v_subrev_u32_sdwa v6, s42, v93 dst_sel:DWORD dst_unused:UNUSED_PAD src0_sel:DWORD src1_sel:WORD_1
  v_cmpx_gt_u32 vcc, s43, v6
  v_lshlrev_b32 v7, 2, v6
  v_lshl_add_u32 v6, v6, 1, s41
  ds_write_b32 v7, v19
  ds_write_b16_d16_hi v6, v58
  s_mov_b64 exec, s[44:45]
  v_subrev_u32_sdwa v4, s42, v94 dst_sel:DWORD dst_unused:UNUSED_PAD src0_sel:DWORD src1_sel:WORD_0
  v_cmpx_gt_u32 vcc, s43, v4
  v_lshlrev_b32 v5, 2, v4
  v_lshl_add_u32 v4, v4, 1, s41
  ds_write_b32 v5, v20
  ds_write_b16 v4, v60
  s_mov_b64 exec, s[44:45]
  v_subrev_u32_sdwa v6, s42, v94 dst_sel:DWORD dst_unused:UNUSED_PAD src0_sel:DWORD src1_sel:WORD_1
  v_cmpx_gt_u32 vcc, s43, v6
  v_lshlrev_b32 v7, 2, v6
  v_lshl_add_u32 v6, v6, 1, s41
  ds_write_b32 v7, v21
  ds_write_b16_d16_hi v6, v60
  s_mov_b64 exec, s[44:45]
  v_subrev_u32_sdwa v4, s42, v95 dst_sel:DWORD dst_unused:UNUSED_PAD src0_sel:DWORD src1_sel:WORD_0
  v_cmpx_gt_u32 vcc, s43, v4
  v_lshlrev_b32 v5, 2, v4
  v_lshl_add_u32 v4, v4, 1, s41
  ds_write_b32 v5, v22
  ds_write_b16 v4, v62
  s_mov_b64 exec, s[44:45]
  v_subrev_u32_sdwa v6, s42, v95 dst_sel:DWORD dst_unused:UNUSED_PAD src0_sel:DWORD src1_sel:WORD_1
  v_cmpx_gt_u32 vcc, s43, v6
  v_lshlrev_b32 v7, 2, v6
  v_lshl_add_u32 v6, v6, 1, s41
  ds_write_b32 v7, v23
  ds_write_b16_d16_hi v6, v62
  s_mov_b64 exec, s[44:45]
  v_subrev_u32_sdwa v4, s42, v96 dst_sel:DWORD dst_unused:UNUSED_PAD src0_sel:DWORD src1_sel:WORD_0
  v_cmpx_gt_u32 vcc, s43, v4
  v_lshlrev_b32 v5, 2, v4
  v_lshl_add_u32 v4, v4, 1, s41
  ds_write_b32 v5, v24
  ds_write_b16 v4, v64
  s_mov_b64 exec, s[44:45]
  v_subrev_u32_sdwa v6, s42, v96 dst_sel:DWORD dst_unused:UNUSED_PAD src0_sel:DWORD src1_sel:WORD_1
  v_cmpx_gt_u32 vcc, s43, v6
  v_lshlrev_b32 v7, 2, v6
  v_lshl_add_u32 v6, v6, 1, s41
  ds_write_b32 v7, v25
  ds_write_b16_d16_hi v6, v64
  s_mov_b64 exec, s[44:45]
  v_subrev_u32_sdwa v4, s42, v97 dst_sel:DWORD dst_unused:UNUSED_PAD src0_sel:DWORD src1_sel:WORD_0
  v_cmpx_gt_u32 vcc, s43, v4
  v_lshlrev_b32 v5, 2, v4
  v_lshl_add_u32 v4, v4, 1, s41
  ds_write_b32 v5, v26
  ds_write_b16 v4, v66
  s_mov_b64 exec, s[44:45]
  v_subrev_u32_sdwa v6, s42, v97 dst_sel:DWORD dst_unused:UNUSED_PAD src0_sel:DWORD src1_sel:WORD_1
  v_cmpx_gt_u32 vcc, s43, v6
  v_lshlrev_b32 v7, 2, v6
  v_lshl_add_u32 v6, v6, 1, s41
  ds_write_b32 v7, v27
  ds_write_b16_d16_hi v6, v66
  s_mov_b64 exec, s[44:45]
  v_subrev_u32_sdwa v4, s42, v98 dst_sel:DWORD dst_unused:UNUSED_PAD src0_sel:DWORD src1_sel:WORD_0
  v_cmpx_gt_u32 vcc, s43, v4
  v_lshlrev_b32 v5, 2, v4
  v_lshl_add_u32 v4, v4, 1, s41
  ds_write_b32 v5, v28
  ds_write_b16 v4, v68
  s_mov_b64 exec, s[44:45]
  v_subrev_u32_sdwa v6, s42, v98 dst_sel:DWORD dst_unused:UNUSED_PAD src0_sel:DWORD src1_sel:WORD_1
  v_cmpx_gt_u32 vcc, s43, v6
  v_lshlrev_b32 v7, 2, v6
  v_lshl_add_u32 v6, v6, 1, s41
  ds_write_b32 v7, v29
  ds_write_b16_d16_hi v6, v68
  s_mov_b64 exec, s[44:45]
  v_subrev_u32_sdwa v4, s42, v99 dst_sel:DWORD dst_unused:UNUSED_PAD src0_sel:DWORD src1_sel:WORD_0
  v_cmpx_gt_u32 vcc, s43, v4
  v_lshlrev_b32 v5, 2, v4
  v_lshl_add_u32 v4, v4, 1, s41
  ds_write_b32 v5, v30
  ds_write_b16 v4, v70
  s_mov_b64 exec, s[44:45]
  v_subrev_u32_sdwa v6, s42, v99 dst_sel:DWORD dst_unused:UNUSED_PAD src0_sel:DWORD src1_sel:WORD_1
  v_cmpx_gt_u32 vcc, s43, v6
  v_lshlrev_b32 v7, 2, v6
  v_lshl_add_u32 v6, v6, 1, s41
  ds_write_b32 v7, v31
  ds_write_b16_d16_hi v6, v70
  s_mov_b64 exec, s[44:45]
  v_subrev_u32_sdwa v4, s42, v100 dst_sel:DWORD dst_unused:UNUSED_PAD src0_sel:DWORD src1_sel:WORD_0
  v_cmpx_gt_u32 vcc, s43, v4
  v_lshlrev_b32 v5, 2, v4
  v_lshl_add_u32 v4, v4, 1, s41
  ds_write_b32 v5, v32
  ds_write_b16 v4, v72
  s_mov_b64 exec, s[44:45]
  v_subrev_u32_sdwa v6, s42, v100 dst_sel:DWORD dst_unused:UNUSED_PAD src0_sel:DWORD src1_sel:WORD_1
  v_cmpx_gt_u32 vcc, s43, v6
  v_lshlrev_b32 v7, 2, v6
  v_lshl_add_u32 v6, v6, 1, s41
  ds_write_b32 v7, v33
  ds_write_b16_d16_hi v6, v72
  s_mov_b64 exec, s[44:45]
  v_subrev_u32_sdwa v4, s42, v101 dst_sel:DWORD dst_unused:UNUSED_PAD src0_sel:DWORD src1_sel:WORD_0
  v_cmpx_gt_u32 vcc, s43, v4
  v_lshlrev_b32 v5, 2, v4
  v_lshl_add_u32 v4, v4, 1, s41
  ds_write_b32 v5, v34
  ds_write_b16 v4, v74
  s_mov_b64 exec, s[44:45]
  v_subrev_u32_sdwa v6, s42, v101 dst_sel:DWORD dst_unused:UNUSED_PAD src0_sel:DWORD src1_sel:WORD_1
  v_cmpx_gt_u32 vcc, s43, v6
  v_lshlrev_b32 v7, 2, v6
  v_lshl_add_u32 v6, v6, 1, s41
  ds_write_b32 v7, v35
  ds_write_b16_d16_hi v6, v74
  s_mov_b64 exec, s[44:45]
  v_subrev_u32_sdwa v4, s42, v102 dst_sel:DWORD dst_unused:UNUSED_PAD src0_sel:DWORD src1_sel:WORD_0
  v_cmpx_gt_u32 vcc, s43, v4
  v_lshlrev_b32 v5, 2, v4
  v_lshl_add_u32 v4, v4, 1, s41
  ds_write_b32 v5, v36
  ds_write_b16 v4, v76
  s_mov_b64 exec, s[44:45]
  v_subrev_u32_sdwa v6, s42, v102 dst_sel:DWORD dst_unused:UNUSED_PAD src0_sel:DWORD src1_sel:WORD_1
  v_cmpx_gt_u32 vcc, s43, v6
  v_lshlrev_b32 v7, 2, v6
  v_lshl_add_u32 v6, v6, 1, s41
  ds_write_b32 v7, v37
  ds_write_b16_d16_hi v6, v76
  s_mov_b64 exec, s[44:45]
  v_subrev_u32_sdwa v4, s42, v103 dst_sel:DWORD dst_unused:UNUSED_PAD src0_sel:DWORD src1_sel:WORD_0
  v_cmpx_gt_u32 vcc, s43, v4
  v_lshlrev_b32 v5, 2, v4
  v_lshl_add_u32 v4, v4, 1, s41
  ds_write_b32 v5, v38
  ds_write_b16 v4, v78
  s_mov_b64 exec, s[44:45]
  v_subrev_u32_sdwa v6, s42, v103 dst_sel:DWORD dst_unused:UNUSED_PAD src0_sel:DWORD src1_sel:WORD_1
  v_cmpx_gt_u32 vcc, s43, v6
  v_lshlrev_b32 v7, 2, v6
  v_lshl_add_u32 v6, v6, 1, s41
  ds_write_b32 v7, v39
  ds_write_b16_d16_hi v6, v78
  s_mov_b64 exec, s[44:45]
  v_subrev_u32_sdwa v4, s42, v104 dst_sel:DWORD dst_unused:UNUSED_PAD src0_sel:DWORD src1_sel:WORD_0
  v_cmpx_gt_u32 vcc, s43, v4
  v_lshlrev_b32 v5, 2, v4
  v_lshl_add_u32 v4, v4, 1, s41
  ds_write_b32 v5, v40
  ds_write_b16 v4, v80
  s_mov_b64 exec, s[44:45]
  v_subrev_u32_sdwa v6, s42, v104 dst_sel:DWORD dst_unused:UNUSED_PAD src0_sel:DWORD src1_sel:WORD_1
  v_cmpx_gt_u32 vcc, s43, v6
  v_lshlrev_b32 v7, 2, v6
  v_lshl_add_u32 v6, v6, 1, s41
  ds_write_b32 v7, v41
  ds_write_b16_d16_hi v6, v80
  s_mov_b64 exec, s[44:45]
  v_subrev_u32_sdwa v4, s42, v105 dst_sel:DWORD dst_unused:UNUSED_PAD src0_sel:DWORD src1_sel:WORD_0
  v_cmpx_gt_u32 vcc, s43, v4
  v_lshlrev_b32 v5, 2, v4
  v_lshl_add_u32 v4, v4, 1, s41
  ds_write_b32 v5, v42
  ds_write_b16 v4, v82
  s_mov_b64 exec, s[44:45]
  v_subrev_u32_sdwa v6, s42, v105 dst_sel:DWORD dst_unused:UNUSED_PAD src0_sel:DWORD src1_sel:WORD_1
  v_cmpx_gt_u32 vcc, s43, v6
  v_lshlrev_b32 v7, 2, v6
  v_lshl_add_u32 v6, v6, 1, s41
  ds_write_b32 v7, v43
  ds_write_b16_d16_hi v6, v82
  s_mov_b64 exec, s[44:45]
  v_subrev_u32_sdwa v4, s42, v106 dst_sel:DWORD dst_unused:UNUSED_PAD src0_sel:DWORD src1_sel:WORD_0
  v_cmpx_gt_u32 vcc, s43, v4
  v_lshlrev_b32 v5, 2, v4
  v_lshl_add_u32 v4, v4, 1, s41
  ds_write_b32 v5, v44
  ds_write_b16 v4, v84
  s_mov_b64 exec, s[44:45]
  v_subrev_u32_sdwa v6, s42, v106 dst_sel:DWORD dst_unused:UNUSED_PAD src0_sel:DWORD src1_sel:WORD_1
  v_cmpx_gt_u32 vcc, s43, v6
  v_lshlrev_b32 v7, 2, v6
  v_lshl_add_u32 v6, v6, 1, s41
  ds_write_b32 v7, v45
  ds_write_b16_d16_hi v6, v84
  s_mov_b64 exec, s[44:45]
  v_subrev_u32_sdwa v4, s42, v107 dst_sel:DWORD dst_unused:UNUSED_PAD src0_sel:DWORD src1_sel:WORD_0
  v_cmpx_gt_u32 vcc, s43, v4
  v_lshlrev_b32 v5, 2, v4
  v_lshl_add_u32 v4, v4, 1, s41
  ds_write_b32 v5, v46
  ds_write_b16 v4, v86
  s_mov_b64 exec, s[44:45]
  v_subrev_u32_sdwa v6, s42, v107 dst_sel:DWORD dst_unused:UNUSED_PAD src0_sel:DWORD src1_sel:WORD_1
  v_cmpx_gt_u32 vcc, s43, v6
  v_lshlrev_b32 v7, 2, v6
  v_lshl_add_u32 v6, v6, 1, s41
  ds_write_b32 v7, v47
  ds_write_b16_d16_hi v6, v86
  s_mov_b64 exec, s[44:45]
  s_mov_b64 exec, -1
  s_add_u32 s16, s28, 147456
  s_addc_u32 s17, s29, 0
  s_and_b32 s17, s17, 0xffff
  s_sub_u32 s18, s72, 1152
  s_lshl_b32 s18, s18, 7
  s_mov_b32 s19, 0x20000
  v_lshlrev_b32 v1, 4, v0
  v_mov_b32 v3, v124
  s_mov_b32 s40, 131072
  s_waitcnt lgkmcnt(0)
  s_barrier
  ds_read2_b64 v[108:111], v3 offset0:0 offset1:1
  v_add_u32 v3, v3, v125
  ds_read2_b64 v[112:115], v3 offset0:0 offset1:1
  v_add_u32 v3, v3, v125
  ds_read2_b64 v[116:119], v3 offset0:0 offset1:1
  v_add_u32 v3, v3, v125
  ds_read2_b64 v[120:123], v3 offset0:0 offset1:1
  v_add_u32 v3, v3, v125
  s_waitcnt lgkmcnt(3)
  buffer_store_dwordx4 v[108:111], v1, s[16:19], 0 offen sc1
  s_waitcnt lgkmcnt(2)
  buffer_store_dwordx4 v[112:115], v1, s[16:19], s33 offen sc1
  s_waitcnt lgkmcnt(1)
  buffer_store_dwordx4 v[116:119], v1, s[16:19], s34 offen sc1
  s_waitcnt lgkmcnt(0)
  buffer_store_dwordx4 v[120:123], v1, s[16:19], s35 offen sc1
  s_nop 1
  ds_read2_b64 v[108:111], v3 offset0:0 offset1:1
  v_add_u32 v3, v3, v125
  ds_read2_b64 v[112:115], v3 offset0:0 offset1:1
  v_add_u32 v3, v3, v125
  ds_read2_b64 v[116:119], v3 offset0:0 offset1:1
  v_add_u32 v3, v3, v125
  ds_read2_b64 v[120:123], v3 offset0:0 offset1:1
  v_add_u32 v3, v3, v125
  s_waitcnt lgkmcnt(3)
  buffer_store_dwordx4 v[108:111], v1, s[16:19], s36 offen sc1
  s_waitcnt lgkmcnt(2)
  buffer_store_dwordx4 v[112:115], v1, s[16:19], s37 offen sc1
  s_waitcnt lgkmcnt(1)
  buffer_store_dwordx4 v[116:119], v1, s[16:19], s38 offen sc1
  s_waitcnt lgkmcnt(0)
  buffer_store_dwordx4 v[120:123], v1, s[16:19], s39 offen sc1
  s_nop 1
  ds_read2_b64 v[108:111], v3 offset0:0 offset1:1
  v_add_u32 v3, v3, v125
  s_waitcnt lgkmcnt(0)
  buffer_store_dwordx4 v[108:111], v1, s[16:19], s40 offen sc1
  s_nop 1
p1_done:
  s_endpgm
.p2align 8
.type p2_kernel,@function
p2_kernel:
  s_cmp_ge_u32 s2, 256
  s_cbranch_scc1 p2_done
  s_load_dwordx2 s[28:29], s[0:1], 104
  s_load_dwordx2 s[32:33], s[0:1], 0
  s_load_dwordx2 s[34:35], s[0:1], 24
  s_load_dwordx2 s[36:37], s[0:1], 40
  s_load_dwordx4 s[40:43], s[0:1], 56
  s_load_dwordx4 s[44:47], s[0:1], 72
  s_load_dwordx2 s[48:49], s[0:1], 88
  v_readfirstlane_b32 s24, v0
  v_and_b32 v37, 63, v0
  v_and_b32 v3, 15, v0
  s_lshr_b32 s24, s24, 6
  v_and_b32 v31, 15, v37
  s_mul_i32 s25, s2, 256
  s_mul_i32 s26, s24, 16
  s_add_u32 s25, s25, s26
  s_lshl_b32 s25, s25, 2
  v_lshlrev_b32 v32, 2, v31
  v_lshrrev_b32 v36, 4, v37
  s_waitcnt lgkmcnt(0)
  s_mov_b32 s12, s28
  s_and_b32 s13, s29, 0xffff
  s_mov_b32 s14, 262144
  s_mov_b32 s15, 0x20000
  buffer_load_dword v8, v32, s[12:15], s25 offen
  s_mov_b32 s4, s32
  s_and_b32 s5, s33, 0xffff
  s_mov_b32 s6, 10240000
  s_mov_b32 s7, 0x20000
  s_mov_b32 s20, s34
  s_and_b32 s21, s35, 0xffff
  s_mov_b32 s22, 640000
  s_mov_b32 s23, 0x20000
  v_lshlrev_b32 v33, 1, v3
  v_lshl_add_u32 v34, v36, 7, v33
  global_load_ushort v26, v34, s[44:45] offset:0
  global_load_ushort v27, v34, s[44:45] offset:32
  global_load_ushort v28, v34, s[44:45] offset:64
  global_load_ushort v29, v34, s[44:45] offset:96
  global_load_ushort v20, v34, s[46:47] offset:0
  global_load_ushort v21, v34, s[46:47] offset:32
  global_load_ushort v22, v34, s[46:47] offset:64
  global_load_ushort v23, v34, s[46:47] offset:96
  v_lshl_add_u32 v34, v36, 5, v33
  global_load_ushort v24, v34, s[42:43] offset:0
  global_load_ushort v25, v34, s[42:43] offset:128
  global_load_ushort v15, v34, s[40:41] offset:0
  global_load_ushort v11, v34, s[40:41] offset:128
  v_lshlrev_b32 v34, 1, v36
  global_load_ushort v108, v34, s[36:37] offset:0
  global_load_ushort v109, v34, s[36:37] offset:8
  s_lshl_b32 s27, s2, 4
  s_add_u32 s26, s24, 0
  s_lshl_b32 s26, s26, 12
  s_add_u32 s26, s26, s27
  s_mov_b32 s70, s26
  v_add_u32 v33, s26, v3
  v_lshlrev_b32 v34, 1, v33
  buffer_load_ushort v110, v34, s[20:23], 0 offen
  s_add_u32 s26, s24, 16
  s_lshl_b32 s26, s26, 12
  s_add_u32 s26, s26, s27
  s_mov_b32 s71, s26
  v_add_u32 v33, s26, v3
  v_lshlrev_b32 v34, 1, v33
  buffer_load_ushort v111, v34, s[20:23], 0 offen
  s_add_u32 s26, s24, 32
  s_lshl_b32 s26, s26, 12
  s_add_u32 s26, s26, s27
  s_mov_b32 s72, s26
  v_add_u32 v33, s26, v3
  v_lshlrev_b32 v34, 1, v33
  buffer_load_ushort v112, v34, s[20:23], 0 offen
  s_add_u32 s26, s24, 48
  s_lshl_b32 s26, s26, 12
  s_add_u32 s26, s26, s27
  s_mov_b32 s73, s26
  v_add_u32 v33, s26, v3
  v_lshlrev_b32 v34, 1, v33
  buffer_load_ushort v113, v34, s[20:23], 0 offen
  s_add_u32 s26, s24, 64
  s_lshl_b32 s26, s26, 12
  s_add_u32 s26, s26, s27
  s_mov_b32 s74, s26
  v_add_u32 v33, s26, v3
  v_lshlrev_b32 v34, 1, v33
  buffer_load_ushort v114, v34, s[20:23], 0 offen
  v_add_u32 v33, s70, v3
  v_lshlrev_b32 v34, 5, v33
  v_lshl_add_u32 v34, v36, 3, v34
  buffer_load_dwordx2 v[46:47], v34, s[4:7], 0 offen
  v_add_u32 v33, s71, v3
  v_lshlrev_b32 v34, 5, v33
  v_lshl_add_u32 v34, v36, 3, v34
  buffer_load_dwordx2 v[48:49], v34, s[4:7], 0 offen
  v_add_u32 v33, s72, v3
  v_lshlrev_b32 v34, 5, v33
  v_lshl_add_u32 v34, v36, 3, v34
  buffer_load_dwordx2 v[50:51], v34, s[4:7], 0 offen
  v_add_u32 v33, s73, v3
  v_lshlrev_b32 v34, 5, v33
  v_lshl_add_u32 v34, v36, 3, v34
  buffer_load_dwordx2 v[52:53], v34, s[4:7], 0 offen
  v_add_u32 v33, s74, v3
  v_lshlrev_b32 v34, 5, v33
  v_lshl_add_u32 v34, v36, 3, v34
  buffer_load_dwordx2 v[54:55], v34, s[4:7], 0 offen
  s_add_u32 s8, s28, 262144
  s_addc_u32 s9, s29, 0
  s_and_b32 s9, s9, 0xffff
  s_mov_b32 s10, 73531392
  s_mov_b32 s11, 0x20000
  s_mov_b32 s16, s48
  s_and_b32 s17, s49, 0xffff
  s_mov_b32 s18, 10240000
  s_mov_b32 s19, 0x20000
  v_lshlrev_b32 v33, 4, v0
  v_mov_b32 v16, 0
  v_mov_b32 v17, 0
  v_mov_b32 v18, 0
  v_mov_b32 v19, 0
  v_add_u32 v34, 0x10000, v33
  v_add_u32 v35, 0x20000, v33
  ds_write_b128 v33, v[16:19] offset:0
  ds_write_b128 v33, v[16:19] offset:16384
  ds_write_b128 v33, v[16:19] offset:32768
  ds_write_b128 v33, v[16:19] offset:49152
  ds_write_b128 v34, v[16:19] offset:0
  ds_write_b128 v34, v[16:19] offset:16384
  ds_write_b128 v34, v[16:19] offset:32768
  ds_write_b128 v34, v[16:19] offset:49152
  ds_write_b128 v35, v[16:19] offset:0
  ds_write_b128 v35, v[16:19] offset:16384
  v_and_b32 v4, 7, v0
  v_lshlrev_b32 v1, 2, v4
  v_lshlrev_b32 v2, 3, v3
  v_lshlrev_b32 v5, 1, v3
  v_cmp_gt_u32 vcc, 8, v3
  v_mov_b32 v33, 0x03020c0c
  v_mov_b32 v34, 0x05040c0c
  v_cndmask_b32 v12, v33, v34, vcc
  v_mov_b32 v33, 0x07060c0c
  v_mov_b32 v34, 0x01000c0c
  v_cndmask_b32 v13, v33, v34, vcc
  v_mul_u32_u24 v10, 20, v36
  v_lshlrev_b32 v6, 7, v36
  s_mul_i32 s26, s24, 16
  v_add_u32 v30, s26, v31
  s_mov_b32 s27, 287232
  v_mul_lo_u32 v30, v30, s27
  s_mov_b32 s52, 0xffffff80
  s_mov_b32 s53, 0xffff0000
  s_mov_b32 s54, 0x3ff80
  s_mov_b32 s55, 0xffffe0
  s_waitcnt vmcnt(24)
  v_lshrrev_b32 v9, 16, v8
  v_and_b32 v8, 0xffff, v8
  v_lshl_add_u32 v9, v9, 7, v30
  v_add_u32 v9, v9, v6
  v_mov_b32 v30, v8
  s_nop 1
  v_max_u32_dpp v30, v30, v30 row_ror:1 row_mask:0xf bank_mask:0xf
  s_nop 1
  v_max_u32_dpp v30, v30, v30 row_ror:2 row_mask:0xf bank_mask:0xf
  s_nop 1
  v_max_u32_dpp v30, v30, v30 row_ror:4 row_mask:0xf bank_mask:0xf
  s_nop 1
  v_max_u32_dpp v30, v30, v30 row_ror:8 row_mask:0xf bank_mask:0xf
  s_nop 1
  v_readlane_b32 s56, v30, 0
  v_readlane_b32 s57, v30, 16
  v_readlane_b32 s58, v30, 32
  v_readlane_b32 s59, v30, 48
  s_nop 3
  s_max_u32 s56, s56, s57
  s_max_u32 s58, s58, s59
  s_max_u32 s50, s56, s58
  s_mov_b32 s51, 0
  s_mov_b32 s56, 0
  s_mov_b32 s64, 0
  s_mov_b32 s69, 30
  s_waitcnt vmcnt(5)
  v_lshl_or_b32 v38, v27, 16, v26
  v_lshl_or_b32 v39, v29, 16, v28
  v_lshl_or_b32 v42, v21, 16, v20
  v_lshl_or_b32 v43, v23, 16, v22
  v_lshl_or_b32 v104, v25, 16, v24
  v_lshl_or_b32 v106, v11, 16, v15
  v_mov_b32 v40, v38
  v_mov_b32 v41, v39
  v_mov_b32 v44, v42
  v_mov_b32 v45, v43
  v_mov_b32 v105, 0
  v_mov_b32 v107, 0
  v_mov_b32 v117, 0
  v_lshlrev_b32 v108, 16, v108
  v_lshlrev_b32 v109, 16, v109
  s_mov_b32 s60, 0
p2_chk0:
  s_cmp_lg_u32 s56, 0
  s_cbranch_scc1 p2_go0
  s_cmp_ge_u32 s51, s50
  s_cbranch_scc1 p2_exh0
  v_add_u32 v30, s51, v10
  v_cmp_gt_u32 vcc, v8, v30
  v_sub_u32 v31, v8, v30
  v_min_u32 v31, 20, v31
  v_add_u32 v32, s60, v9
  v_or_b32 v32, v32, v31
  s_bcnt1_i32_b64 s67, vcc
  v_mbcnt_lo_u32_b32 v33, vcc_lo, 0
  v_mbcnt_hi_u32_b32 v33, vcc_hi, v33
  v_sub_u32 v34, v37, v33
  v_add_u32 v34, s67, v34
  v_cndmask_b32 v34, v34, v33, vcc
  v_cndmask_b32 v32, 0, v32, vcc
  v_and_b32 v35, 3, v34
  v_lshlrev_b32 v35, 6, v35
  v_and_or_b32 v35, v34, -4, v35
  ds_permute_b32 v11, v35, v32
  s_add_u32 s56, s67, 3
  s_lshr_b32 s56, s56, 2
  s_add_u32 s64, s64, s56
  s_add_u32 s51, s51, 80
  s_add_u32 s60, s60, 512
  s_waitcnt lgkmcnt(0)
  s_branch p2_go0
p2_exh0:
  v_mov_b32 v11, 0
  s_mov_b32 s56, 1
  s_nop 0
p2_go0:
  s_sub_u32 s56, s56, 1
  v_mov_b32_dpp v30, v11 row_newbcast:0 row_mask:0xf bank_mask:0xf
  v_mov_b32_dpp v11, v11 row_shl:1 row_mask:0xf bank_mask:0xf bound_ctrl:0
  v_and_or_b32 v31, v30, s52, v2
  v_and_b32 v90, 31, v30
  buffer_load_dwordx2 v[86:87], v31, s[8:11], 0 offen nt
p2_chk1:
  s_cmp_lg_u32 s56, 0
  s_cbranch_scc1 p2_go1
  s_cmp_ge_u32 s51, s50
  s_cbranch_scc1 p2_exh1
  v_add_u32 v30, s51, v10
  v_cmp_gt_u32 vcc, v8, v30
  v_sub_u32 v31, v8, v30
  v_min_u32 v31, 20, v31
  v_add_u32 v32, s60, v9
  v_or_b32 v32, v32, v31
  s_bcnt1_i32_b64 s67, vcc
  v_mbcnt_lo_u32_b32 v33, vcc_lo, 0
  v_mbcnt_hi_u32_b32 v33, vcc_hi, v33
  v_sub_u32 v34, v37, v33
  v_add_u32 v34, s67, v34
  v_cndmask_b32 v34, v34, v33, vcc
  v_cndmask_b32 v32, 0, v32, vcc
  v_and_b32 v35, 3, v34
  v_lshlrev_b32 v35, 6, v35
  v_and_or_b32 v35, v34, -4, v35
  ds_permute_b32 v11, v35, v32
  s_add_u32 s56, s67, 3
  s_lshr_b32 s56, s56, 2
  s_add_u32 s64, s64, s56
  s_add_u32 s51, s51, 80
  s_add_u32 s60, s60, 512
  s_waitcnt lgkmcnt(0)
  s_branch p2_go1
p2_exh1:
  v_mov_b32 v11, 0
  s_mov_b32 s56, 1
  s_nop 0
p2_go1:
  s_sub_u32 s56, s56, 1
  v_mov_b32_dpp v30, v11 row_newbcast:0 row_mask:0xf bank_mask:0xf
  v_mov_b32_dpp v11, v11 row_shl:1 row_mask:0xf bank_mask:0xf bound_ctrl:0
  v_and_or_b32 v31, v30, s52, v2
  v_and_b32 v91, 31, v30
  buffer_load_dwordx2 v[88:89], v31, s[8:11], 0 offen nt
  s_mov_b32 s76, 0xc1200000
  s_mov_b32 s77, 0x3fb8aa3b
  v_lshlrev_b32 v31, 16, v110
  v_sub_f32 v32, v31, v108
  v_sub_f32 v33, v31, v109
  v_cvt_pk_bf16_f32 v34, v32, v33
  v_lshlrev_b32 v32, 16, v34
  v_and_b32 v33, s53, v34
  v_mul_f32 v32, v32, v32
  v_mul_f32 v33, v33, v33
  v_cvt_pk_bf16_f32 v34, v32, v33
  v_lshlrev_b32 v32, 16, v34
  v_and_b32 v33, s53, v34
  v_mul_f32 v32, s76, v32
  v_mul_f32 v33, s76, v33
  v_cvt_pk_bf16_f32 v34, v32, v33
  v_lshlrev_b32 v32, 16, v34
  v_and_b32 v33, s53, v34
  v_mul_f32 v32, s77, v32
  v_mul_f32 v33, s77, v33
  v_exp_f32 v32, v32
  v_exp_f32 v33, v33
  s_nop 0
  v_cvt_pk_bf16_f32 v116, v32, v33
  s_nop 1
  v_mfma_f32_16x16x16_bf16 v[56:59], v[104:105], v[116:117], 0
  v_mfma_f32_16x16x16_bf16 v[16:19], v[106:107], v[116:117], 0
  s_nop 7
  s_nop 1
  v_cvt_pk_bf16_f32 v76, v16, v17
  v_cvt_pk_bf16_f32 v77, v18, v19
  v_lshlrev_b32 v31, 16, v111
  v_sub_f32 v32, v31, v108
  v_sub_f32 v33, v31, v109
  v_cvt_pk_bf16_f32 v34, v32, v33
  v_lshlrev_b32 v32, 16, v34
  v_and_b32 v33, s53, v34
  v_mul_f32 v32, v32, v32
  v_mul_f32 v33, v33, v33
  v_cvt_pk_bf16_f32 v34, v32, v33
  v_lshlrev_b32 v32, 16, v34
  v_and_b32 v33, s53, v34
  v_mul_f32 v32, s76, v32
  v_mul_f32 v33, s76, v33
  v_cvt_pk_bf16_f32 v34, v32, v33
  v_lshlrev_b32 v32, 16, v34
  v_and_b32 v33, s53, v34
  v_mul_f32 v32, s77, v32
  v_mul_f32 v33, s77, v33
  v_exp_f32 v32, v32
  v_exp_f32 v33, v33
  s_nop 0
  v_cvt_pk_bf16_f32 v116, v32, v33
  s_nop 1
  v_mfma_f32_16x16x16_bf16 v[60:63], v[104:105], v[116:117], 0
  v_mfma_f32_16x16x16_bf16 v[16:19], v[106:107], v[116:117], 0
  s_nop 7
  s_nop 1
  v_cvt_pk_bf16_f32 v78, v16, v17
  v_cvt_pk_bf16_f32 v79, v18, v19
  v_lshlrev_b32 v31, 16, v112
  v_sub_f32 v32, v31, v108
  v_sub_f32 v33, v31, v109
  v_cvt_pk_bf16_f32 v34, v32, v33
  v_lshlrev_b32 v32, 16, v34
  v_and_b32 v33, s53, v34
  v_mul_f32 v32, v32, v32
  v_mul_f32 v33, v33, v33
  v_cvt_pk_bf16_f32 v34, v32, v33
  v_lshlrev_b32 v32, 16, v34
  v_and_b32 v33, s53, v34
  v_mul_f32 v32, s76, v32
  v_mul_f32 v33, s76, v33
  v_cvt_pk_bf16_f32 v34, v32, v33
  v_lshlrev_b32 v32, 16, v34
  v_and_b32 v33, s53, v34
  v_mul_f32 v32, s77, v32
  v_mul_f32 v33, s77, v33
  v_exp_f32 v32, v32
  v_exp_f32 v33, v33
  s_nop 0
  v_cvt_pk_bf16_f32 v116, v32, v33
  s_nop 1
  v_mfma_f32_16x16x16_bf16 v[64:67], v[104:105], v[116:117], 0
  v_mfma_f32_16x16x16_bf16 v[16:19], v[106:107], v[116:117], 0
  s_nop 7
  s_nop 1
  v_cvt_pk_bf16_f32 v80, v16, v17
  v_cvt_pk_bf16_f32 v81, v18, v19
  v_lshlrev_b32 v31, 16, v113
  v_sub_f32 v32, v31, v108
  v_sub_f32 v33, v31, v109
  v_cvt_pk_bf16_f32 v34, v32, v33
  v_lshlrev_b32 v32, 16, v34
  v_and_b32 v33, s53, v34
  v_mul_f32 v32, v32, v32
  v_mul_f32 v33, v33, v33
  v_cvt_pk_bf16_f32 v34, v32, v33
  v_lshlrev_b32 v32, 16, v34
  v_and_b32 v33, s53, v34
  v_mul_f32 v32, s76, v32
  v_mul_f32 v33, s76, v33
  v_cvt_pk_bf16_f32 v34, v32, v33
  v_lshlrev_b32 v32, 16, v34
  v_and_b32 v33, s53, v34
  v_mul_f32 v32, s77, v32
  v_mul_f32 v33, s77, v33
  v_exp_f32 v32, v32
  v_exp_f32 v33, v33
  s_nop 0
  v_cvt_pk_bf16_f32 v116, v32, v33
  s_nop 1
  v_mfma_f32_16x16x16_bf16 v[68:71], v[104:105], v[116:117], 0
  v_mfma_f32_16x16x16_bf16 v[16:19], v[106:107], v[116:117], 0
  s_nop 7
  s_nop 1
  v_cvt_pk_bf16_f32 v82, v16, v17
  v_cvt_pk_bf16_f32 v83, v18, v19
  v_lshlrev_b32 v31, 16, v114
  v_sub_f32 v32, v31, v108
  v_sub_f32 v33, v31, v109
  v_cvt_pk_bf16_f32 v34, v32, v33
  v_lshlrev_b32 v32, 16, v34
  v_and_b32 v33, s53, v34
  v_mul_f32 v32, v32, v32
  v_mul_f32 v33, v33, v33
  v_cvt_pk_bf16_f32 v34, v32, v33
  v_lshlrev_b32 v32, 16, v34
  v_and_b32 v33, s53, v34
  v_mul_f32 v32, s76, v32
  v_mul_f32 v33, s76, v33
  v_cvt_pk_bf16_f32 v34, v32, v33
  v_lshlrev_b32 v32, 16, v34
  v_and_b32 v33, s53, v34
  v_mul_f32 v32, s77, v32
  v_mul_f32 v33, s77, v33
  v_exp_f32 v32, v32
  v_exp_f32 v33, v33
  s_nop 0
  v_cvt_pk_bf16_f32 v116, v32, v33
  s_nop 1
  v_mfma_f32_16x16x16_bf16 v[72:75], v[104:105], v[116:117], 0
  v_mfma_f32_16x16x16_bf16 v[16:19], v[106:107], v[116:117], 0
  s_nop 7
  s_nop 1
  v_cvt_pk_bf16_f32 v84, v16, v17
  v_cvt_pk_bf16_f32 v85, v18, v19
  s_waitcnt vmcnt(1)
  v_mov_b32 v14, 161792
  v_cmp_gt_u32 vcc, v90, v5
  v_or_b32 v34, 1, v5
  v_cmp_gt_u32 s[58:59], v90, v34
  v_lshlrev_b32 v32, 5, v86
  v_lshrrev_b32 v33, 12, v86
  v_and_b32 v32, s55, v32
  v_and_b32 v33, s54, v33
  v_cndmask_b32 v15, 0, v32, vcc
  v_cndmask_b32 v100, v14, v33, vcc
  v_lshlrev_b32 v32, 5, v87
  v_lshrrev_b32 v33, 12, v87
  v_and_b32 v32, s55, v32
  v_and_b32 v33, s54, v33
  v_cndmask_b32 v7, 0, v32, s[58:59]
  v_cndmask_b32 v101, v14, v33, s[58:59]
  v_lshlrev_b32 v92, 16, v86
  v_lshlrev_b32 v93, 16, v87
  v_and_b32 v96, s53, v86
  v_and_b32 v97, s53, v87
  v_add_u32_dpp v24, v15, v1 row_newbcast:0 row_mask:0xf bank_mask:0x3
  v_add_u32_dpp v24, v7, v1 row_newbcast:0 row_mask:0xf bank_mask:0xc
  buffer_load_dword v104, v24, s[4:7], 0 offen
  v_add_u32_dpp v25, v15, v1 row_newbcast:1 row_mask:0xf bank_mask:0x3
  v_add_u32_dpp v25, v7, v1 row_newbcast:1 row_mask:0xf bank_mask:0xc
  buffer_load_dword v105, v25, s[4:7], 0 offen
  v_add_u32_dpp v24, v15, v1 row_newbcast:2 row_mask:0xf bank_mask:0x3
  v_add_u32_dpp v24, v7, v1 row_newbcast:2 row_mask:0xf bank_mask:0xc
  buffer_load_dword v106, v24, s[4:7], 0 offen
  v_add_u32_dpp v25, v15, v1 row_newbcast:3 row_mask:0xf bank_mask:0x3
  v_add_u32_dpp v25, v7, v1 row_newbcast:3 row_mask:0xf bank_mask:0xc
  buffer_load_dword v107, v25, s[4:7], 0 offen
  v_add_u32_dpp v24, v15, v1 row_newbcast:4 row_mask:0xf bank_mask:0x3
  v_add_u32_dpp v24, v7, v1 row_newbcast:4 row_mask:0xf bank_mask:0xc
  buffer_load_dword v108, v24, s[4:7], 0 offen
  v_add_u32_dpp v25, v15, v1 row_newbcast:5 row_mask:0xf bank_mask:0x3
  v_add_u32_dpp v25, v7, v1 row_newbcast:5 row_mask:0xf bank_mask:0xc
  buffer_load_dword v109, v25, s[4:7], 0 offen
  v_add_u32_dpp v24, v15, v1 row_newbcast:6 row_mask:0xf bank_mask:0x3
  v_add_u32_dpp v24, v7, v1 row_newbcast:6 row_mask:0xf bank_mask:0xc
  buffer_load_dword v110, v24, s[4:7], 0 offen
  v_add_u32_dpp v25, v15, v1 row_newbcast:7 row_mask:0xf bank_mask:0x3
  v_add_u32_dpp v25, v7, v1 row_newbcast:7 row_mask:0xf bank_mask:0xc
  buffer_load_dword v111, v25, s[4:7], 0 offen
  v_add_u32_dpp v24, v15, v1 row_newbcast:8 row_mask:0xf bank_mask:0x3
  v_add_u32_dpp v24, v7, v1 row_newbcast:8 row_mask:0xf bank_mask:0xc
  buffer_load_dword v112, v24, s[4:7], 0 offen
  v_add_u32_dpp v25, v15, v1 row_newbcast:9 row_mask:0xf bank_mask:0x3
  v_add_u32_dpp v25, v7, v1 row_newbcast:9 row_mask:0xf bank_mask:0xc
  buffer_load_dword v113, v25, s[4:7], 0 offen
  s_waitcnt lgkmcnt(0)
  s_barrier
  s_cmp_eq_u32 s64, 0
  s_cbranch_scc1 p2_loop_exit
p2_loop:
p2_chk2:
  s_cmp_lg_u32 s56, 0
  s_cbranch_scc1 p2_go2
  s_cmp_ge_u32 s51, s50
  s_cbranch_scc1 p2_exh2
  v_add_u32 v30, s51, v10
  v_cmp_gt_u32 vcc, v8, v30
  v_sub_u32 v31, v8, v30
  v_min_u32 v31, 20, v31
  v_add_u32 v32, s60, v9
  v_or_b32 v32, v32, v31
  s_bcnt1_i32_b64 s67, vcc
  v_mbcnt_lo_u32_b32 v33, vcc_lo, 0
  v_mbcnt_hi_u32_b32 v33, vcc_hi, v33
  v_sub_u32 v34, v37, v33
  v_add_u32 v34, s67, v34
  v_cndmask_b32 v34, v34, v33, vcc
  v_cndmask_b32 v32, 0, v32, vcc
  v_and_b32 v35, 3, v34
  v_lshlrev_b32 v35, 6, v35
  v_and_or_b32 v35, v34, -4, v35
  ds_permute_b32 v11, v35, v32
  s_add_u32 s56, s67, 3
  s_lshr_b32 s56, s56, 2
  s_add_u32 s64, s64, s56
  s_add_u32 s51, s51, 80
  s_add_u32 s60, s60, 512
  s_waitcnt lgkmcnt(0)
  s_branch p2_go2
p2_exh2:
  v_mov_b32 v11, 0
  s_mov_b32 s56, 1
  s_nop 0
p2_go2:
  s_sub_u32 s56, s56, 1
  v_mov_b32_dpp v30, v11 row_newbcast:0 row_mask:0xf bank_mask:0xf
  v_mov_b32_dpp v11, v11 row_shl:1 row_mask:0xf bank_mask:0xf bound_ctrl:0
  v_and_or_b32 v31, v30, s52, v2
  v_and_b32 v90, 31, v30
  buffer_load_dwordx2 v[86:87], v31, s[8:11], 0 offen nt
  s_waitcnt vmcnt(11)
  v_cmp_gt_u32 vcc, v91, v5
  v_or_b32 v34, 1, v5
  v_cmp_gt_u32 s[58:59], v91, v34
  v_lshlrev_b32 v32, 5, v88
  v_lshrrev_b32 v33, 12, v88
  v_and_b32 v32, s55, v32
  v_and_b32 v33, s54, v33
  v_cndmask_b32 v15, 0, v32, vcc
  v_cndmask_b32 v102, v14, v33, vcc
  v_lshlrev_b32 v32, 5, v89
  v_lshrrev_b32 v33, 12, v89
  v_and_b32 v32, s55, v32
  v_and_b32 v33, s54, v33
  v_cndmask_b32 v7, 0, v32, s[58:59]
  v_cndmask_b32 v103, v14, v33, s[58:59]
  v_lshlrev_b32 v94, 16, v88
  v_lshlrev_b32 v95, 16, v89
  v_and_b32 v98, s53, v88
  v_and_b32 v99, s53, v89
  v_add_u32_dpp v24, v15, v1 row_newbcast:0 row_mask:0xf bank_mask:0x3
  v_add_u32_dpp v24, v7, v1 row_newbcast:0 row_mask:0xf bank_mask:0xc
  buffer_load_dword v114, v24, s[4:7], 0 offen
  s_waitcnt vmcnt(11)
  v_mov_b32_dpp v26, v104 row_ror:8 row_mask:0xf bank_mask:0xf
  v_add_u32_dpp v22, v100, v2 row_newbcast:0 row_mask:0xf bank_mask:0xf
  v_add_u32_dpp v23, v101, v2 row_newbcast:0 row_mask:0xf bank_mask:0xf
  v_perm_b32 v28, v104, v26, v12
  v_perm_b32 v29, v104, v26, v13
  v_mul_f32_dpp v20, v92, v28 row_newbcast:10 row_mask:0xf bank_mask:0xf
  v_mul_f32_dpp v21, v96, v29 row_newbcast:10 row_mask:0xf bank_mask:0xf
  v_cvt_f64_f32 v[16:17], v20
  v_cvt_f64_f32 v[18:19], v21
  ds_add_f64 v22, v[16:17]
  ds_add_f64 v23, v[18:19]
  v_add_u32_dpp v25, v15, v1 row_newbcast:1 row_mask:0xf bank_mask:0x3
  v_add_u32_dpp v25, v7, v1 row_newbcast:1 row_mask:0xf bank_mask:0xc
  buffer_load_dword v115, v25, s[4:7], 0 offen
  s_waitcnt vmcnt(11)
  v_mov_b32_dpp v27, v105 row_ror:8 row_mask:0xf bank_mask:0xf
  v_add_u32_dpp v22, v100, v2 row_newbcast:1 row_mask:0xf bank_mask:0xf
  v_add_u32_dpp v23, v101, v2 row_newbcast:1 row_mask:0xf bank_mask:0xf
  v_perm_b32 v28, v105, v27, v12
  v_perm_b32 v29, v105, v27, v13
  v_mul_f32_dpp v20, v93, v28 row_newbcast:10 row_mask:0xf bank_mask:0xf
  v_mul_f32_dpp v21, v97, v29 row_newbcast:10 row_mask:0xf bank_mask:0xf
  v_cvt_f64_f32 v[16:17], v20
  v_cvt_f64_f32 v[18:19], v21
  ds_add_f64 v22, v[16:17]
  ds_add_f64 v23, v[18:19]
  v_add_u32_dpp v24, v15, v1 row_newbcast:2 row_mask:0xf bank_mask:0x3
  v_add_u32_dpp v24, v7, v1 row_newbcast:2 row_mask:0xf bank_mask:0xc
  buffer_load_dword v116, v24, s[4:7], 0 offen
  s_waitcnt vmcnt(11)
  v_mov_b32_dpp v26, v106 row_ror:8 row_mask:0xf bank_mask:0xf
  v_add_u32_dpp v22, v100, v2 row_newbcast:2 row_mask:0xf bank_mask:0xf
  v_add_u32_dpp v23, v101, v2 row_newbcast:2 row_mask:0xf bank_mask:0xf
  v_perm_b32 v28, v106, v26, v12
  v_perm_b32 v29, v106, v26, v13
  v_mul_f32_dpp v20, v92, v28 row_newbcast:11 row_mask:0xf bank_mask:0xf
  v_mul_f32_dpp v21, v96, v29 row_newbcast:11 row_mask:0xf bank_mask:0xf
  v_cvt_f64_f32 v[16:17], v20
  v_cvt_f64_f32 v[18:19], v21
  ds_add_f64 v22, v[16:17]
  ds_add_f64 v23, v[18:19]
  v_add_u32_dpp v25, v15, v1 row_newbcast:3 row_mask:0xf bank_mask:0x3
  v_add_u32_dpp v25, v7, v1 row_newbcast:3 row_mask:0xf bank_mask:0xc
  buffer_load_dword v117, v25, s[4:7], 0 offen
  s_waitcnt vmcnt(11)
  v_mov_b32_dpp v27, v107 row_ror:8 row_mask:0xf bank_mask:0xf
  v_add_u32_dpp v22, v100, v2 row_newbcast:3 row_mask:0xf bank_mask:0xf
  v_add_u32_dpp v23, v101, v2 row_newbcast:3 row_mask:0xf bank_mask:0xf
  v_perm_b32 v28, v107, v27, v12
  v_perm_b32 v29, v107, v27, v13
  v_mul_f32_dpp v20, v93, v28 row_newbcast:11 row_mask:0xf bank_mask:0xf
  v_mul_f32_dpp v21, v97, v29 row_newbcast:11 row_mask:0xf bank_mask:0xf
  v_cvt_f64_f32 v[16:17], v20
  v_cvt_f64_f32 v[18:19], v21
  ds_add_f64 v22, v[16:17]
  ds_add_f64 v23, v[18:19]
  v_add_u32_dpp v24, v15, v1 row_newbcast:4 row_mask:0xf bank_mask:0x3
  v_add_u32_dpp v24, v7, v1 row_newbcast:4 row_mask:0xf bank_mask:0xc
  buffer_load_dword v118, v24, s[4:7], 0 offen
  s_waitcnt vmcnt(11)
  v_mov_b32_dpp v26, v108 row_ror:8 row_mask:0xf bank_mask:0xf
  v_add_u32_dpp v22, v100, v2 row_newbcast:4 row_mask:0xf bank_mask:0xf
  v_add_u32_dpp v23, v101, v2 row_newbcast:4 row_mask:0xf bank_mask:0xf
  v_perm_b32 v28, v108, v26, v12
  v_perm_b32 v29, v108, v26, v13
  v_mul_f32_dpp v20, v92, v28 row_newbcast:12 row_mask:0xf bank_mask:0xf
  v_mul_f32_dpp v21, v96, v29 row_newbcast:12 row_mask:0xf bank_mask:0xf
  v_cvt_f64_f32 v[16:17], v20
  v_cvt_f64_f32 v[18:19], v21
  ds_add_f64 v22, v[16:17]
  ds_add_f64 v23, v[18:19]
  v_add_u32_dpp v25, v15, v1 row_newbcast:5 row_mask:0xf bank_mask:0x3
  v_add_u32_dpp v25, v7, v1 row_newbcast:5 row_mask:0xf bank_mask:0xc
  buffer_load_dword v119, v25, s[4:7], 0 offen
  s_waitcnt vmcnt(11)
  v_mov_b32_dpp v27, v109 row_ror:8 row_mask:0xf bank_mask:0xf
  v_add_u32_dpp v22, v100, v2 row_newbcast:5 row_mask:0xf bank_mask:0xf
  v_add_u32_dpp v23, v101, v2 row_newbcast:5 row_mask:0xf bank_mask:0xf
  v_perm_b32 v28, v109, v27, v12
  v_perm_b32 v29, v109, v27, v13
  v_mul_f32_dpp v20, v93, v28 row_newbcast:12 row_mask:0xf bank_mask:0xf
  v_mul_f32_dpp v21, v97, v29 row_newbcast:12 row_mask:0xf bank_mask:0xf
  v_cvt_f64_f32 v[16:17], v20
  v_cvt_f64_f32 v[18:19], v21
  ds_add_f64 v22, v[16:17]
  ds_add_f64 v23, v[18:19]
  v_add_u32_dpp v24, v15, v1 row_newbcast:6 row_mask:0xf bank_mask:0x3
  v_add_u32_dpp v24, v7, v1 row_newbcast:6 row_mask:0xf bank_mask:0xc
  buffer_load_dword v120, v24, s[4:7], 0 offen
  s_waitcnt vmcnt(11)
  v_mov_b32_dpp v26, v110 row_ror:8 row_mask:0xf bank_mask:0xf
  v_add_u32_dpp v22, v100, v2 row_newbcast:6 row_mask:0xf bank_mask:0xf
  v_add_u32_dpp v23, v101, v2 row_newbcast:6 row_mask:0xf bank_mask:0xf
  v_perm_b32 v28, v110, v26, v12
  v_perm_b32 v29, v110, v26, v13
  v_mul_f32_dpp v20, v92, v28 row_newbcast:13 row_mask:0xf bank_mask:0xf
  v_mul_f32_dpp v21, v96, v29 row_newbcast:13 row_mask:0xf bank_mask:0xf
  v_cvt_f64_f32 v[16:17], v20
  v_cvt_f64_f32 v[18:19], v21
  ds_add_f64 v22, v[16:17]
  ds_add_f64 v23, v[18:19]
  v_add_u32_dpp v25, v15, v1 row_newbcast:7 row_mask:0xf bank_mask:0x3
  v_add_u32_dpp v25, v7, v1 row_newbcast:7 row_mask:0xf bank_mask:0xc
  buffer_load_dword v121, v25, s[4:7], 0 offen
  s_waitcnt vmcnt(11)
  v_mov_b32_dpp v27, v111 row_ror:8 row_mask:0xf bank_mask:0xf
  v_add_u32_dpp v22, v100, v2 row_newbcast:7 row_mask:0xf bank_mask:0xf
  v_add_u32_dpp v23, v101, v2 row_newbcast:7 row_mask:0xf bank_mask:0xf
  v_perm_b32 v28, v111, v27, v12
  v_perm_b32 v29, v111, v27, v13
  v_mul_f32_dpp v20, v93, v28 row_newbcast:13 row_mask:0xf bank_mask:0xf
  v_mul_f32_dpp v21, v97, v29 row_newbcast:13 row_mask:0xf bank_mask:0xf
  v_cvt_f64_f32 v[16:17], v20
  v_cvt_f64_f32 v[18:19], v21
  ds_add_f64 v22, v[16:17]
  ds_add_f64 v23, v[18:19]
  v_add_u32_dpp v24, v15, v1 row_newbcast:8 row_mask:0xf bank_mask:0x3
  v_add_u32_dpp v24, v7, v1 row_newbcast:8 row_mask:0xf bank_mask:0xc
  buffer_load_dword v122, v24, s[4:7], 0 offen
  s_waitcnt vmcnt(11)
  v_mov_b32_dpp v26, v112 row_ror:8 row_mask:0xf bank_mask:0xf
  v_add_u32_dpp v22, v100, v2 row_newbcast:8 row_mask:0xf bank_mask:0xf
  v_add_u32_dpp v23, v101, v2 row_newbcast:8 row_mask:0xf bank_mask:0xf
  v_perm_b32 v28, v112, v26, v12
  v_perm_b32 v29, v112, v26, v13
  v_mul_f32_dpp v20, v92, v28 row_newbcast:14 row_mask:0xf bank_mask:0xf
  v_mul_f32_dpp v21, v96, v29 row_newbcast:14 row_mask:0xf bank_mask:0xf
  v_cvt_f64_f32 v[16:17], v20
  v_cvt_f64_f32 v[18:19], v21
  ds_add_f64 v22, v[16:17]
  ds_add_f64 v23, v[18:19]
  v_add_u32_dpp v25, v15, v1 row_newbcast:9 row_mask:0xf bank_mask:0x3
  v_add_u32_dpp v25, v7, v1 row_newbcast:9 row_mask:0xf bank_mask:0xc
  buffer_load_dword v123, v25, s[4:7], 0 offen
  s_waitcnt vmcnt(11)
  v_mov_b32_dpp v27, v113 row_ror:8 row_mask:0xf bank_mask:0xf
  v_add_u32_dpp v22, v100, v2 row_newbcast:9 row_mask:0xf bank_mask:0xf
  v_add_u32_dpp v23, v101, v2 row_newbcast:9 row_mask:0xf bank_mask:0xf
  v_perm_b32 v28, v113, v27, v12
  v_perm_b32 v29, v113, v27, v13
  v_mul_f32_dpp v20, v93, v28 row_newbcast:14 row_mask:0xf bank_mask:0xf
  v_mul_f32_dpp v21, v97, v29 row_newbcast:14 row_mask:0xf bank_mask:0xf
  v_cvt_f64_f32 v[16:17], v20
  v_cvt_f64_f32 v[18:19], v21
  ds_add_f64 v22, v[16:17]
  ds_add_f64 v23, v[18:19]
  s_cmp_eq_u32 s69, 0
  s_cbranch_scc1 p2_nosync0
  s_barrier
  s_sub_u32 s69, s69, 1
p2_nosync0:
  s_sub_u32 s64, s64, 1
  s_cmp_eq_u32 s64, 0
  s_cbranch_scc1 p2_loop_exit
p2_chk3:
  s_cmp_lg_u32 s56, 0
  s_cbranch_scc1 p2_go3
  s_cmp_ge_u32 s51, s50
  s_cbranch_scc1 p2_exh3
  v_add_u32 v30, s51, v10
  v_cmp_gt_u32 vcc, v8, v30
  v_sub_u32 v31, v8, v30
  v_min_u32 v31, 20, v31
  v_add_u32 v32, s60, v9
  v_or_b32 v32, v32, v31
  s_bcnt1_i32_b64 s67, vcc
  v_mbcnt_lo_u32_b32 v33, vcc_lo, 0
  v_mbcnt_hi_u32_b32 v33, vcc_hi, v33
  v_sub_u32 v34, v37, v33
  v_add_u32 v34, s67, v34
  v_cndmask_b32 v34, v34, v33, vcc
  v_cndmask_b32 v32, 0, v32, vcc
  v_and_b32 v35, 3, v34
  v_lshlrev_b32 v35, 6, v35
  v_and_or_b32 v35, v34, -4, v35
  ds_permute_b32 v11, v35, v32
  s_add_u32 s56, s67, 3
  s_lshr_b32 s56, s56, 2
  s_add_u32 s64, s64, s56
  s_add_u32 s51, s51, 80
  s_add_u32 s60, s60, 512
  s_waitcnt lgkmcnt(0)
  s_branch p2_go3
p2_exh3:
  v_mov_b32 v11, 0
  s_mov_b32 s56, 1
  s_nop 0
p2_go3:
  s_sub_u32 s56, s56, 1
  v_mov_b32_dpp v30, v11 row_newbcast:0 row_mask:0xf bank_mask:0xf
  v_mov_b32_dpp v11, v11 row_shl:1 row_mask:0xf bank_mask:0xf bound_ctrl:0
  v_and_or_b32 v31, v30, s52, v2
  v_and_b32 v91, 31, v30
  buffer_load_dwordx2 v[88:89], v31, s[8:11], 0 offen nt
  s_waitcnt vmcnt(11)
  v_cmp_gt_u32 vcc, v90, v5
  v_or_b32 v34, 1, v5
  v_cmp_gt_u32 s[58:59], v90, v34
  v_lshlrev_b32 v32, 5, v86
  v_lshrrev_b32 v33, 12, v86
  v_and_b32 v32, s55, v32
  v_and_b32 v33, s54, v33
  v_cndmask_b32 v15, 0, v32, vcc
  v_cndmask_b32 v100, v14, v33, vcc
  v_lshlrev_b32 v32, 5, v87
  v_lshrrev_b32 v33, 12, v87
  v_and_b32 v32, s55, v32
  v_and_b32 v33, s54, v33
  v_cndmask_b32 v7, 0, v32, s[58:59]
  v_cndmask_b32 v101, v14, v33, s[58:59]
  v_lshlrev_b32 v92, 16, v86
  v_lshlrev_b32 v93, 16, v87
  v_and_b32 v96, s53, v86
  v_and_b32 v97, s53, v87
  v_add_u32_dpp v24, v15, v1 row_newbcast:0 row_mask:0xf bank_mask:0x3
  v_add_u32_dpp v24, v7, v1 row_newbcast:0 row_mask:0xf bank_mask:0xc
  buffer_load_dword v104, v24, s[4:7], 0 offen
  s_waitcnt vmcnt(11)
  v_mov_b32_dpp v26, v114 row_ror:8 row_mask:0xf bank_mask:0xf
  v_add_u32_dpp v22, v102, v2 row_newbcast:0 row_mask:0xf bank_mask:0xf
  v_add_u32_dpp v23, v103, v2 row_newbcast:0 row_mask:0xf bank_mask:0xf
  v_perm_b32 v28, v114, v26, v12
  v_perm_b32 v29, v114, v26, v13
  v_mul_f32_dpp v20, v94, v28 row_newbcast:10 row_mask:0xf bank_mask:0xf
  v_mul_f32_dpp v21, v98, v29 row_newbcast:10 row_mask:0xf bank_mask:0xf
  v_cvt_f64_f32 v[16:17], v20
  v_cvt_f64_f32 v[18:19], v21
  ds_add_f64 v22, v[16:17]
  ds_add_f64 v23, v[18:19]
  v_add_u32_dpp v25, v15, v1 row_newbcast:1 row_mask:0xf bank_mask:0x3
  v_add_u32_dpp v25, v7, v1 row_newbcast:1 row_mask:0xf bank_mask:0xc
  buffer_load_dword v105, v25, s[4:7], 0 offen
  s_waitcnt vmcnt(11)
  v_mov_b32_dpp v27, v115 row_ror:8 row_mask:0xf bank_mask:0xf
  v_add_u32_dpp v22, v102, v2 row_newbcast:1 row_mask:0xf bank_mask:0xf
  v_add_u32_dpp v23, v103, v2 row_newbcast:1 row_mask:0xf bank_mask:0xf
  v_perm_b32 v28, v115, v27, v12
  v_perm_b32 v29, v115, v27, v13
  v_mul_f32_dpp v20, v95, v28 row_newbcast:10 row_mask:0xf bank_mask:0xf
  v_mul_f32_dpp v21, v99, v29 row_newbcast:10 row_mask:0xf bank_mask:0xf
  v_cvt_f64_f32 v[16:17], v20
  v_cvt_f64_f32 v[18:19], v21
  ds_add_f64 v22, v[16:17]
  ds_add_f64 v23, v[18:19]
  v_add_u32_dpp v24, v15, v1 row_newbcast:2 row_mask:0xf bank_mask:0x3
  v_add_u32_dpp v24, v7, v1 row_newbcast:2 row_mask:0xf bank_mask:0xc
  buffer_load_dword v106, v24, s[4:7], 0 offen
  s_waitcnt vmcnt(11)
  v_mov_b32_dpp v26, v116 row_ror:8 row_mask:0xf bank_mask:0xf
  v_add_u32_dpp v22, v102, v2 row_newbcast:2 row_mask:0xf bank_mask:0xf
  v_add_u32_dpp v23, v103, v2 row_newbcast:2 row_mask:0xf bank_mask:0xf
  v_perm_b32 v28, v116, v26, v12
  v_perm_b32 v29, v116, v26, v13
  v_mul_f32_dpp v20, v94, v28 row_newbcast:11 row_mask:0xf bank_mask:0xf
  v_mul_f32_dpp v21, v98, v29 row_newbcast:11 row_mask:0xf bank_mask:0xf
  v_cvt_f64_f32 v[16:17], v20
  v_cvt_f64_f32 v[18:19], v21
  ds_add_f64 v22, v[16:17]
  ds_add_f64 v23, v[18:19]
  v_add_u32_dpp v25, v15, v1 row_newbcast:3 row_mask:0xf bank_mask:0x3
  v_add_u32_dpp v25, v7, v1 row_newbcast:3 row_mask:0xf bank_mask:0xc
  buffer_load_dword v107, v25, s[4:7], 0 offen
  s_waitcnt vmcnt(11)
  v_mov_b32_dpp v27, v117 row_ror:8 row_mask:0xf bank_mask:0xf
  v_add_u32_dpp v22, v102, v2 row_newbcast:3 row_mask:0xf bank_mask:0xf
  v_add_u32_dpp v23, v103, v2 row_newbcast:3 row_mask:0xf bank_mask:0xf
  v_perm_b32 v28, v117, v27, v12
  v_perm_b32 v29, v117, v27, v13
  v_mul_f32_dpp v20, v95, v28 row_newbcast:11 row_mask:0xf bank_mask:0xf
  v_mul_f32_dpp v21, v99, v29 row_newbcast:11 row_mask:0xf bank_mask:0xf
  v_cvt_f64_f32 v[16:17], v20
  v_cvt_f64_f32 v[18:19], v21
  ds_add_f64 v22, v[16:17]
  ds_add_f64 v23, v[18:19]
  v_add_u32_dpp v24, v15, v1 row_newbcast:4 row_mask:0xf bank_mask:0x3
  v_add_u32_dpp v24, v7, v1 row_newbcast:4 row_mask:0xf bank_mask:0xc
  buffer_load_dword v108, v24, s[4:7], 0 offen
  s_waitcnt vmcnt(11)
  v_mov_b32_dpp v26, v118 row_ror:8 row_mask:0xf bank_mask:0xf
  v_add_u32_dpp v22, v102, v2 row_newbcast:4 row_mask:0xf bank_mask:0xf
  v_add_u32_dpp v23, v103, v2 row_newbcast:4 row_mask:0xf bank_mask:0xf
  v_perm_b32 v28, v118, v26, v12
  v_perm_b32 v29, v118, v26, v13
  v_mul_f32_dpp v20, v94, v28 row_newbcast:12 row_mask:0xf bank_mask:0xf
  v_mul_f32_dpp v21, v98, v29 row_newbcast:12 row_mask:0xf bank_mask:0xf
  v_cvt_f64_f32 v[16:17], v20
  v_cvt_f64_f32 v[18:19], v21
  ds_add_f64 v22, v[16:17]
  ds_add_f64 v23, v[18:19]
  v_add_u32_dpp v25, v15, v1 row_newbcast:5 row_mask:0xf bank_mask:0x3
  v_add_u32_dpp v25, v7, v1 row_newbcast:5 row_mask:0xf bank_mask:0xc
  buffer_load_dword v109, v25, s[4:7], 0 offen
  s_waitcnt vmcnt(11)
  v_mov_b32_dpp v27, v119 row_ror:8 row_mask:0xf bank_mask:0xf
  v_add_u32_dpp v22, v102, v2 row_newbcast:5 row_mask:0xf bank_mask:0xf
  v_add_u32_dpp v23, v103, v2 row_newbcast:5 row_mask:0xf bank_mask:0xf
  v_perm_b32 v28, v119, v27, v12
  v_perm_b32 v29, v119, v27, v13
  v_mul_f32_dpp v20, v95, v28 row_newbcast:12 row_mask:0xf bank_mask:0xf
  v_mul_f32_dpp v21, v99, v29 row_newbcast:12 row_mask:0xf bank_mask:0xf
  v_cvt_f64_f32 v[16:17], v20
  v_cvt_f64_f32 v[18:19], v21
  ds_add_f64 v22, v[16:17]
  ds_add_f64 v23, v[18:19]
  v_add_u32_dpp v24, v15, v1 row_newbcast:6 row_mask:0xf bank_mask:0x3
  v_add_u32_dpp v24, v7, v1 row_newbcast:6 row_mask:0xf bank_mask:0xc
  buffer_load_dword v110, v24, s[4:7], 0 offen
  s_waitcnt vmcnt(11)
  v_mov_b32_dpp v26, v120 row_ror:8 row_mask:0xf bank_mask:0xf
  v_add_u32_dpp v22, v102, v2 row_newbcast:6 row_mask:0xf bank_mask:0xf
  v_add_u32_dpp v23, v103, v2 row_newbcast:6 row_mask:0xf bank_mask:0xf
  v_perm_b32 v28, v120, v26, v12
  v_perm_b32 v29, v120, v26, v13
  v_mul_f32_dpp v20, v94, v28 row_newbcast:13 row_mask:0xf bank_mask:0xf
  v_mul_f32_dpp v21, v98, v29 row_newbcast:13 row_mask:0xf bank_mask:0xf
  v_cvt_f64_f32 v[16:17], v20
  v_cvt_f64_f32 v[18:19], v21
  ds_add_f64 v22, v[16:17]
  ds_add_f64 v23, v[18:19]
  v_add_u32_dpp v25, v15, v1 row_newbcast:7 row_mask:0xf bank_mask:0x3
  v_add_u32_dpp v25, v7, v1 row_newbcast:7 row_mask:0xf bank_mask:0xc
  buffer_load_dword v111, v25, s[4:7], 0 offen
  s_waitcnt vmcnt(11)
  v_mov_b32_dpp v27, v121 row_ror:8 row_mask:0xf bank_mask:0xf
  v_add_u32_dpp v22, v102, v2 row_newbcast:7 row_mask:0xf bank_mask:0xf
  v_add_u32_dpp v23, v103, v2 row_newbcast:7 row_mask:0xf bank_mask:0xf
  v_perm_b32 v28, v121, v27, v12
  v_perm_b32 v29, v121, v27, v13
  v_mul_f32_dpp v20, v95, v28 row_newbcast:13 row_mask:0xf bank_mask:0xf
  v_mul_f32_dpp v21, v99, v29 row_newbcast:13 row_mask:0xf bank_mask:0xf
  v_cvt_f64_f32 v[16:17], v20
  v_cvt_f64_f32 v[18:19], v21
  ds_add_f64 v22, v[16:17]
  ds_add_f64 v23, v[18:19]
  v_add_u32_dpp v24, v15, v1 row_newbcast:8 row_mask:0xf bank_mask:0x3
  v_add_u32_dpp v24, v7, v1 row_newbcast:8 row_mask:0xf bank_mask:0xc
  buffer_load_dword v112, v24, s[4:7], 0 offen
  s_waitcnt vmcnt(11)
  v_mov_b32_dpp v26, v122 row_ror:8 row_mask:0xf bank_mask:0xf
  v_add_u32_dpp v22, v102, v2 row_newbcast:8 row_mask:0xf bank_mask:0xf
  v_add_u32_dpp v23, v103, v2 row_newbcast:8 row_mask:0xf bank_mask:0xf
  v_perm_b32 v28, v122, v26, v12
  v_perm_b32 v29, v122, v26, v13
  v_mul_f32_dpp v20, v94, v28 row_newbcast:14 row_mask:0xf bank_mask:0xf
  v_mul_f32_dpp v21, v98, v29 row_newbcast:14 row_mask:0xf bank_mask:0xf
  v_cvt_f64_f32 v[16:17], v20
  v_cvt_f64_f32 v[18:19], v21
  ds_add_f64 v22, v[16:17]
  ds_add_f64 v23, v[18:19]
  v_add_u32_dpp v25, v15, v1 row_newbcast:9 row_mask:0xf bank_mask:0x3
  v_add_u32_dpp v25, v7, v1 row_newbcast:9 row_mask:0xf bank_mask:0xc
  buffer_load_dword v113, v25, s[4:7], 0 offen
  s_waitcnt vmcnt(11)
  v_mov_b32_dpp v27, v123 row_ror:8 row_mask:0xf bank_mask:0xf
  v_add_u32_dpp v22, v102, v2 row_newbcast:9 row_mask:0xf bank_mask:0xf
  v_add_u32_dpp v23, v103, v2 row_newbcast:9 row_mask:0xf bank_mask:0xf
  v_perm_b32 v28, v123, v27, v12
  v_perm_b32 v29, v123, v27, v13
  v_mul_f32_dpp v20, v95, v28 row_newbcast:14 row_mask:0xf bank_mask:0xf
  v_mul_f32_dpp v21, v99, v29 row_newbcast:14 row_mask:0xf bank_mask:0xf
  v_cvt_f64_f32 v[16:17], v20
  v_cvt_f64_f32 v[18:19], v21
  ds_add_f64 v22, v[16:17]
  ds_add_f64 v23, v[18:19]
  s_cmp_eq_u32 s69, 0
  s_cbranch_scc1 p2_nosync1
  s_barrier
  s_sub_u32 s69, s69, 1
p2_nosync1:
  s_sub_u32 s64, s64, 1
  s_cmp_eq_u32 s64, 0
  s_cbranch_scc0 p2_loop
p2_loop_exit:
p2_owed:
  s_cmp_eq_u32 s69, 0
  s_cbranch_scc1 p2_owed_done
  s_barrier
  s_sub_u32 s69, s69, 1
  s_branch p2_owed
p2_owed_done:
  s_waitcnt vmcnt(0) lgkmcnt(0)
  s_barrier
  s_cmp_ge_u32 s70, 320000
  s_cbranch_scc1 p2_epi_skip0
  s_add_u32 s26, s24, 0
  s_lshl_b32 s26, s26, 11
  v_lshlrev_b32 v30, 7, v3
  v_lshl_add_u32 v30, v36, 4, v30
  v_add_u32 v30, s26, v30
  ds_read_b128 v[86:89], v30
  ds_read_b128 v[90:93], v30 offset:64
  s_waitcnt lgkmcnt(0)
  v_cvt_f32_f64 v94, v[86:87]
  v_cvt_f32_f64 v96, v[88:89]
  v_cvt_f32_f64 v95, v[90:91]
  v_cvt_f32_f64 v97, v[92:93]
  v_cvt_pk_bf16_f32 v98, v94, v95
  v_cvt_pk_bf16_f32 v99, v96, v97
  v_lshlrev_b32 v30, 16, v98
  v_and_b32 v31, s53, v98
  v_lshlrev_b32 v32, 16, v99
  v_and_b32 v33, s53, v99
  v_sub_f32 v30, v94, v30
  v_sub_f32 v31, v95, v31
  v_sub_f32 v32, v96, v32
  v_sub_f32 v33, v97, v33
  v_cvt_pk_bf16_f32 v100, v30, v31
  v_cvt_pk_bf16_f32 v101, v32, v33
  s_nop 1
  v_mfma_f32_16x16x32_bf16 v[102:105], v[38:41], v[98:101], 0
  s_nop 7
  s_nop 1
  v_mul_f32 v102, v102, v56
  v_mul_f32 v103, v103, v57
  v_mul_f32 v104, v104, v58
  v_mul_f32 v105, v105, v59
  v_cvt_pk_bf16_f32 v98, v102, v103
  v_cvt_pk_bf16_f32 v99, v104, v105
  v_lshlrev_b32 v30, 16, v98
  v_and_b32 v31, s53, v98
  v_lshlrev_b32 v32, 16, v99
  v_and_b32 v33, s53, v99
  v_sub_f32 v30, v102, v30
  v_sub_f32 v31, v103, v31
  v_sub_f32 v32, v104, v32
  v_sub_f32 v33, v105, v33
  v_cvt_pk_bf16_f32 v100, v30, v31
  v_cvt_pk_bf16_f32 v101, v32, v33
  s_nop 1
  v_mfma_f32_16x16x32_bf16 v[106:109], v[42:45], v[98:101], 0
  v_lshlrev_b32 v94, 16, v76
  v_and_b32 v95, s53, v76
  v_lshlrev_b32 v96, 16, v77
  v_and_b32 v97, s53, v77
  v_lshlrev_b32 v102, 16, v46
  v_and_b32 v103, s53, v46
  v_lshlrev_b32 v104, 16, v47
  v_and_b32 v105, s53, v47
  s_nop 1
  v_cvt_pk_bf16_f32 v30, v106, v107
  v_cvt_pk_bf16_f32 v31, v108, v109
  v_lshlrev_b32 v106, 16, v30
  v_and_b32 v107, s53, v30
  v_lshlrev_b32 v108, 16, v31
  v_and_b32 v109, s53, v31
  v_mul_f32 v106, v106, v94
  v_mul_f32 v107, v107, v95
  v_mul_f32 v108, v108, v96
  v_mul_f32 v109, v109, v97
  v_cvt_pk_bf16_f32 v30, v106, v107
  v_cvt_pk_bf16_f32 v31, v108, v109
  v_lshlrev_b32 v106, 16, v30
  v_and_b32 v107, s53, v30
  v_lshlrev_b32 v108, 16, v31
  v_and_b32 v109, s53, v31
  v_add_f32 v106, v106, v102
  v_add_f32 v107, v107, v103
  v_add_f32 v108, v108, v104
  v_add_f32 v109, v109, v105
  v_cvt_pk_bf16_f32 v106, v106, v107
  v_cvt_pk_bf16_f32 v107, v108, v109
  v_add_u32 v33, s70, v3
  v_lshlrev_b32 v34, 5, v33
  v_lshl_add_u32 v34, v36, 3, v34
  buffer_store_dwordx2 v[106:107], v34, s[16:19], 0 offen sc1
p2_epi_skip0:
  s_cmp_ge_u32 s71, 320000
  s_cbranch_scc1 p2_epi_skip1
  s_add_u32 s26, s24, 16
  s_lshl_b32 s26, s26, 11
  v_lshlrev_b32 v30, 7, v3
  v_lshl_add_u32 v30, v36, 4, v30
  v_add_u32 v30, s26, v30
  ds_read_b128 v[86:89], v30
  ds_read_b128 v[90:93], v30 offset:64
  s_waitcnt lgkmcnt(0)
  v_cvt_f32_f64 v94, v[86:87]
  v_cvt_f32_f64 v96, v[88:89]
  v_cvt_f32_f64 v95, v[90:91]
  v_cvt_f32_f64 v97, v[92:93]
  v_cvt_pk_bf16_f32 v98, v94, v95
  v_cvt_pk_bf16_f32 v99, v96, v97
  v_lshlrev_b32 v30, 16, v98
  v_and_b32 v31, s53, v98
  v_lshlrev_b32 v32, 16, v99
  v_and_b32 v33, s53, v99
  v_sub_f32 v30, v94, v30
  v_sub_f32 v31, v95, v31
  v_sub_f32 v32, v96, v32
  v_sub_f32 v33, v97, v33
  v_cvt_pk_bf16_f32 v100, v30, v31
  v_cvt_pk_bf16_f32 v101, v32, v33
  s_nop 1
  v_mfma_f32_16x16x32_bf16 v[102:105], v[38:41], v[98:101], 0
  s_nop 7
  s_nop 1
  v_mul_f32 v102, v102, v60
  v_mul_f32 v103, v103, v61
  v_mul_f32 v104, v104, v62
  v_mul_f32 v105, v105, v63
  v_cvt_pk_bf16_f32 v98, v102, v103
  v_cvt_pk_bf16_f32 v99, v104, v105
  v_lshlrev_b32 v30, 16, v98
  v_and_b32 v31, s53, v98
  v_lshlrev_b32 v32, 16, v99
  v_and_b32 v33, s53, v99
  v_sub_f32 v30, v102, v30
  v_sub_f32 v31, v103, v31
  v_sub_f32 v32, v104, v32
  v_sub_f32 v33, v105, v33
  v_cvt_pk_bf16_f32 v100, v30, v31
  v_cvt_pk_bf16_f32 v101, v32, v33
  s_nop 1
  v_mfma_f32_16x16x32_bf16 v[106:109], v[42:45], v[98:101], 0
  v_lshlrev_b32 v94, 16, v78
  v_and_b32 v95, s53, v78
  v_lshlrev_b32 v96, 16, v79
  v_and_b32 v97, s53, v79
  v_lshlrev_b32 v102, 16, v48
  v_and_b32 v103, s53, v48
  v_lshlrev_b32 v104, 16, v49
  v_and_b32 v105, s53, v49
  s_nop 1
  v_cvt_pk_bf16_f32 v30, v106, v107
  v_cvt_pk_bf16_f32 v31, v108, v109
  v_lshlrev_b32 v106, 16, v30
  v_and_b32 v107, s53, v30
  v_lshlrev_b32 v108, 16, v31
  v_and_b32 v109, s53, v31
  v_mul_f32 v106, v106, v94
  v_mul_f32 v107, v107, v95
  v_mul_f32 v108, v108, v96
  v_mul_f32 v109, v109, v97
  v_cvt_pk_bf16_f32 v30, v106, v107
  v_cvt_pk_bf16_f32 v31, v108, v109
  v_lshlrev_b32 v106, 16, v30
  v_and_b32 v107, s53, v30
  v_lshlrev_b32 v108, 16, v31
  v_and_b32 v109, s53, v31
  v_add_f32 v106, v106, v102
  v_add_f32 v107, v107, v103
  v_add_f32 v108, v108, v104
  v_add_f32 v109, v109, v105
  v_cvt_pk_bf16_f32 v106, v106, v107
  v_cvt_pk_bf16_f32 v107, v108, v109
  v_add_u32 v33, s71, v3
  v_lshlrev_b32 v34, 5, v33
  v_lshl_add_u32 v34, v36, 3, v34
  buffer_store_dwordx2 v[106:107], v34, s[16:19], 0 offen sc1
p2_epi_skip1:
  s_cmp_ge_u32 s72, 320000
  s_cbranch_scc1 p2_epi_skip2
  s_add_u32 s26, s24, 32
  s_lshl_b32 s26, s26, 11
  v_lshlrev_b32 v30, 7, v3
  v_lshl_add_u32 v30, v36, 4, v30
  v_add_u32 v30, s26, v30
  ds_read_b128 v[86:89], v30
  ds_read_b128 v[90:93], v30 offset:64
  s_waitcnt lgkmcnt(0)
  v_cvt_f32_f64 v94, v[86:87]
  v_cvt_f32_f64 v96, v[88:89]
  v_cvt_f32_f64 v95, v[90:91]
  v_cvt_f32_f64 v97, v[92:93]
  v_cvt_pk_bf16_f32 v98, v94, v95
  v_cvt_pk_bf16_f32 v99, v96, v97
  v_lshlrev_b32 v30, 16, v98
  v_and_b32 v31, s53, v98
  v_lshlrev_b32 v32, 16, v99
  v_and_b32 v33, s53, v99
  v_sub_f32 v30, v94, v30
  v_sub_f32 v31, v95, v31
  v_sub_f32 v32, v96, v32
  v_sub_f32 v33, v97, v33
  v_cvt_pk_bf16_f32 v100, v30, v31
  v_cvt_pk_bf16_f32 v101, v32, v33
  s_nop 1
  v_mfma_f32_16x16x32_bf16 v[102:105], v[38:41], v[98:101], 0
  s_nop 7
  s_nop 1
  v_mul_f32 v102, v102, v64
  v_mul_f32 v103, v103, v65
  v_mul_f32 v104, v104, v66
  v_mul_f32 v105, v105, v67
  v_cvt_pk_bf16_f32 v98, v102, v103
  v_cvt_pk_bf16_f32 v99, v104, v105
  v_lshlrev_b32 v30, 16, v98
  v_and_b32 v31, s53, v98
  v_lshlrev_b32 v32, 16, v99
  v_and_b32 v33, s53, v99
  v_sub_f32 v30, v102, v30
  v_sub_f32 v31, v103, v31
  v_sub_f32 v32, v104, v32
  v_sub_f32 v33, v105, v33
  v_cvt_pk_bf16_f32 v100, v30, v31
  v_cvt_pk_bf16_f32 v101, v32, v33
  s_nop 1
  v_mfma_f32_16x16x32_bf16 v[106:109], v[42:45], v[98:101], 0
  v_lshlrev_b32 v94, 16, v80
  v_and_b32 v95, s53, v80
  v_lshlrev_b32 v96, 16, v81
  v_and_b32 v97, s53, v81
  v_lshlrev_b32 v102, 16, v50
  v_and_b32 v103, s53, v50
  v_lshlrev_b32 v104, 16, v51
  v_and_b32 v105, s53, v51
  s_nop 1
  v_cvt_pk_bf16_f32 v30, v106, v107
  v_cvt_pk_bf16_f32 v31, v108, v109
  v_lshlrev_b32 v106, 16, v30
  v_and_b32 v107, s53, v30
  v_lshlrev_b32 v108, 16, v31
  v_and_b32 v109, s53, v31
  v_mul_f32 v106, v106, v94
  v_mul_f32 v107, v107, v95
  v_mul_f32 v108, v108, v96
  v_mul_f32 v109, v109, v97
  v_cvt_pk_bf16_f32 v30, v106, v107
  v_cvt_pk_bf16_f32 v31, v108, v109
  v_lshlrev_b32 v106, 16, v30
  v_and_b32 v107, s53, v30
  v_lshlrev_b32 v108, 16, v31
  v_and_b32 v109, s53, v31
  v_add_f32 v106, v106, v102
  v_add_f32 v107, v107, v103
  v_add_f32 v108, v108, v104
  v_add_f32 v109, v109, v105
  v_cvt_pk_bf16_f32 v106, v106, v107
  v_cvt_pk_bf16_f32 v107, v108, v109
  v_add_u32 v33, s72, v3
  v_lshlrev_b32 v34, 5, v33
  v_lshl_add_u32 v34, v36, 3, v34
  buffer_store_dwordx2 v[106:107], v34, s[16:19], 0 offen sc1
p2_epi_skip2:
  s_cmp_ge_u32 s73, 320000
  s_cbranch_scc1 p2_epi_skip3
  s_add_u32 s26, s24, 48
  s_lshl_b32 s26, s26, 11
  v_lshlrev_b32 v30, 7, v3
  v_lshl_add_u32 v30, v36, 4, v30
  v_add_u32 v30, s26, v30
  ds_read_b128 v[86:89], v30
  ds_read_b128 v[90:93], v30 offset:64
  s_waitcnt lgkmcnt(0)
  v_cvt_f32_f64 v94, v[86:87]
  v_cvt_f32_f64 v96, v[88:89]
  v_cvt_f32_f64 v95, v[90:91]
  v_cvt_f32_f64 v97, v[92:93]
  v_cvt_pk_bf16_f32 v98, v94, v95
  v_cvt_pk_bf16_f32 v99, v96, v97
  v_lshlrev_b32 v30, 16, v98
  v_and_b32 v31, s53, v98
  v_lshlrev_b32 v32, 16, v99
  v_and_b32 v33, s53, v99
  v_sub_f32 v30, v94, v30
  v_sub_f32 v31, v95, v31
  v_sub_f32 v32, v96, v32
  v_sub_f32 v33, v97, v33
  v_cvt_pk_bf16_f32 v100, v30, v31
  v_cvt_pk_bf16_f32 v101, v32, v33
  s_nop 1
  v_mfma_f32_16x16x32_bf16 v[102:105], v[38:41], v[98:101], 0
  s_nop 7
  s_nop 1
  v_mul_f32 v102, v102, v68
  v_mul_f32 v103, v103, v69
  v_mul_f32 v104, v104, v70
  v_mul_f32 v105, v105, v71
  v_cvt_pk_bf16_f32 v98, v102, v103
  v_cvt_pk_bf16_f32 v99, v104, v105
  v_lshlrev_b32 v30, 16, v98
  v_and_b32 v31, s53, v98
  v_lshlrev_b32 v32, 16, v99
  v_and_b32 v33, s53, v99
  v_sub_f32 v30, v102, v30
  v_sub_f32 v31, v103, v31
  v_sub_f32 v32, v104, v32
  v_sub_f32 v33, v105, v33
  v_cvt_pk_bf16_f32 v100, v30, v31
  v_cvt_pk_bf16_f32 v101, v32, v33
  s_nop 1
  v_mfma_f32_16x16x32_bf16 v[106:109], v[42:45], v[98:101], 0
  v_lshlrev_b32 v94, 16, v82
  v_and_b32 v95, s53, v82
  v_lshlrev_b32 v96, 16, v83
  v_and_b32 v97, s53, v83
  v_lshlrev_b32 v102, 16, v52
  v_and_b32 v103, s53, v52
  v_lshlrev_b32 v104, 16, v53
  v_and_b32 v105, s53, v53
  s_nop 1
  v_cvt_pk_bf16_f32 v30, v106, v107
  v_cvt_pk_bf16_f32 v31, v108, v109
  v_lshlrev_b32 v106, 16, v30
  v_and_b32 v107, s53, v30
  v_lshlrev_b32 v108, 16, v31
  v_and_b32 v109, s53, v31
  v_mul_f32 v106, v106, v94
  v_mul_f32 v107, v107, v95
  v_mul_f32 v108, v108, v96
  v_mul_f32 v109, v109, v97
  v_cvt_pk_bf16_f32 v30, v106, v107
  v_cvt_pk_bf16_f32 v31, v108, v109
  v_lshlrev_b32 v106, 16, v30
  v_and_b32 v107, s53, v30
  v_lshlrev_b32 v108, 16, v31
  v_and_b32 v109, s53, v31
  v_add_f32 v106, v106, v102
  v_add_f32 v107, v107, v103
  v_add_f32 v108, v108, v104
  v_add_f32 v109, v109, v105
  v_cvt_pk_bf16_f32 v106, v106, v107
  v_cvt_pk_bf16_f32 v107, v108, v109
  v_add_u32 v33, s73, v3
  v_lshlrev_b32 v34, 5, v33
  v_lshl_add_u32 v34, v36, 3, v34
  buffer_store_dwordx2 v[106:107], v34, s[16:19], 0 offen sc1
p2_epi_skip3:
  s_cmp_ge_u32 s74, 320000
  s_cbranch_scc1 p2_epi_skip4
  s_add_u32 s26, s24, 64
  s_lshl_b32 s26, s26, 11
  v_lshlrev_b32 v30, 7, v3
  v_lshl_add_u32 v30, v36, 4, v30
  v_add_u32 v30, s26, v30
  ds_read_b128 v[86:89], v30
  ds_read_b128 v[90:93], v30 offset:64
  s_waitcnt lgkmcnt(0)
  v_cvt_f32_f64 v94, v[86:87]
  v_cvt_f32_f64 v96, v[88:89]
  v_cvt_f32_f64 v95, v[90:91]
  v_cvt_f32_f64 v97, v[92:93]
  v_cvt_pk_bf16_f32 v98, v94, v95
  v_cvt_pk_bf16_f32 v99, v96, v97
  v_lshlrev_b32 v30, 16, v98
  v_and_b32 v31, s53, v98
  v_lshlrev_b32 v32, 16, v99
  v_and_b32 v33, s53, v99
  v_sub_f32 v30, v94, v30
  v_sub_f32 v31, v95, v31
  v_sub_f32 v32, v96, v32
  v_sub_f32 v33, v97, v33
  v_cvt_pk_bf16_f32 v100, v30, v31
  v_cvt_pk_bf16_f32 v101, v32, v33
  s_nop 1
  v_mfma_f32_16x16x32_bf16 v[102:105], v[38:41], v[98:101], 0
  s_nop 7
  s_nop 1
  v_mul_f32 v102, v102, v72
  v_mul_f32 v103, v103, v73
  v_mul_f32 v104, v104, v74
  v_mul_f32 v105, v105, v75
  v_cvt_pk_bf16_f32 v98, v102, v103
  v_cvt_pk_bf16_f32 v99, v104, v105
  v_lshlrev_b32 v30, 16, v98
  v_and_b32 v31, s53, v98
  v_lshlrev_b32 v32, 16, v99
  v_and_b32 v33, s53, v99
  v_sub_f32 v30, v102, v30
  v_sub_f32 v31, v103, v31
  v_sub_f32 v32, v104, v32
  v_sub_f32 v33, v105, v33
  v_cvt_pk_bf16_f32 v100, v30, v31
  v_cvt_pk_bf16_f32 v101, v32, v33
  s_nop 1
  v_mfma_f32_16x16x32_bf16 v[106:109], v[42:45], v[98:101], 0
  v_lshlrev_b32 v94, 16, v84
  v_and_b32 v95, s53, v84
  v_lshlrev_b32 v96, 16, v85
  v_and_b32 v97, s53, v85
  v_lshlrev_b32 v102, 16, v54
  v_and_b32 v103, s53, v54
  v_lshlrev_b32 v104, 16, v55
  v_and_b32 v105, s53, v55
  s_nop 1
  v_cvt_pk_bf16_f32 v30, v106, v107
  v_cvt_pk_bf16_f32 v31, v108, v109
  v_lshlrev_b32 v106, 16, v30
  v_and_b32 v107, s53, v30
  v_lshlrev_b32 v108, 16, v31
  v_and_b32 v109, s53, v31
  v_mul_f32 v106, v106, v94
  v_mul_f32 v107, v107, v95
  v_mul_f32 v108, v108, v96
  v_mul_f32 v109, v109, v97
  v_cvt_pk_bf16_f32 v30, v106, v107
  v_cvt_pk_bf16_f32 v31, v108, v109
  v_lshlrev_b32 v106, 16, v30
  v_and_b32 v107, s53, v30
  v_lshlrev_b32 v108, 16, v31
  v_and_b32 v109, s53, v31
  v_add_f32 v106, v106, v102
  v_add_f32 v107, v107, v103
  v_add_f32 v108, v108, v104
  v_add_f32 v109, v109, v105
  v_cvt_pk_bf16_f32 v106, v106, v107
  v_cvt_pk_bf16_f32 v107, v108, v109
  v_add_u32 v33, s74, v3
  v_lshlrev_b32 v34, 5, v33
  v_lshl_add_u32 v34, v36, 3, v34
  buffer_store_dwordx2 v[106:107], v34, s[16:19], 0 offen sc1
p2_epi_skip4:
p2_done:
  s_endpgm
.section .rodata,"a"
.p2align 6
.amdhsa_kernel p1_kernel
  .amdhsa_next_free_vgpr 128
  .amdhsa_next_free_sgpr 80
  .amdhsa_accum_offset 128
  .amdhsa_group_segment_fixed_size 0
  .amdhsa_kernarg_size 112
  .amdhsa_user_sgpr_count 2
  .amdhsa_user_sgpr_kernarg_segment_ptr 1
  .amdhsa_system_sgpr_workgroup_id_x 1
  .amdhsa_float_denorm_mode_32 3
.end_amdhsa_kernel
.p2align 6
.amdhsa_kernel p2_kernel
  .amdhsa_next_free_vgpr 124
  .amdhsa_next_free_sgpr 80
  .amdhsa_accum_offset 124
  .amdhsa_group_segment_fixed_size 0
  .amdhsa_kernarg_size 112
  .amdhsa_user_sgpr_count 2
  .amdhsa_user_sgpr_kernarg_segment_ptr 1
  .amdhsa_system_sgpr_workgroup_id_x 1
  .amdhsa_float_denorm_mode_32 3
.end_amdhsa_kernel
```
